```python
import torch

def _softmax(x, axis=-1):
    return torch.softmax(x, dim=axis)
def _gelu(x):
    return torch.nn.functional.gelu(x, approximate="tanh")
def _silu(x):
    return torch.nn.functional.silu(x)
def _sigmoid(x):
    return torch.sigmoid(x)
def _layernorm(x, axis=-1, eps=1e-5):
    m = x.mean(dim=axis, keepdim=True)
    v = x.var(dim=axis, keepdim=True, unbiased=False)
    return (x - m) / torch.sqrt(v + eps)
def _scatter_add(tgt, idx, src, axis=0):
    return tgt.clone().index_add_(axis, idx, src)
def _segment_sum(src, seg, n):
    out = torch.zeros((n,) + src.shape[1:], dtype=src.dtype)
    return out.index_add_(0, seg, src)
def _pad(x, pw):
    flat = tuple(v for pair in reversed(pw) for v in pair)
    return torch.nn.functional.pad(x, flat)

kernel_name = 'recurrent_scan__ssm_conv_h3__dense_activation_silu__prompt'

def setup_inputs():

    _w = (lambda a: (lambda t: t.to(torch.bfloat16) if t.is_floating_point() else t)(torch.as_tensor(a)))
    def _A_setup():
        B, S, D = 1, 2048, 512
        ks = 4
        return {
            "q": _w((lambda *s: torch.randn(*s, dtype=torch.bfloat16) * 0.05)(B, S, D)),
            "k": _w((lambda *s: torch.randn(*s, dtype=torch.bfloat16) * 0.8)(B, S, D)),
            "v": _w((lambda *s: torch.randn(*s, dtype=torch.bfloat16) * 0.8)(B, S, D)),
            "shift_k": _w((lambda *s: torch.randn(*s, dtype=torch.bfloat16) * 0.8)(D, ks) * 0.5),
            "ssm_k": _w((lambda *s: torch.randn(*s, dtype=torch.bfloat16) * 0.8)(D, S) * (1.0 / S ** 0.5)),
            "ssm_D": _w((lambda *s: torch.randn(*s, dtype=torch.bfloat16) * 0.8)(D)),
        }
    _A_in = _A_setup()

    def _B_setup():
        B, S, D, F = 1, 2048, 512, 1792
        return {
            "x": _w((lambda *s: torch.randn(*s, dtype=torch.bfloat16) * 0.05)(B, S, D)),
            "w1": _w((lambda *s: torch.randn(*s, dtype=torch.bfloat16) * 0.8)(D, F) * (D ** -0.5)),
            "w2": _w((lambda *s: torch.randn(*s, dtype=torch.bfloat16) * 0.2)(F, D) * (F ** -0.5)),
        }
    _B_in = _B_setup()

    return {
        "A_q": _A_in["q"],
        "A_k": _A_in["k"],
        "A_v": _A_in["v"],
        "A_shift_k": _A_in["shift_k"],
        "A_ssm_k": _A_in["ssm_k"],
        "A_ssm_D": _A_in["ssm_D"],
        "B_x": _B_in["x"],
        "B_w1": _B_in["w1"],
        "B_w2": _B_in["w2"],
    }

def reference(A_q, A_k, A_v, A_shift_k, A_ssm_k, A_ssm_D, B_x, B_w1, B_w2):
    def _A_ref(q, k, v, shift_k, ssm_k, ssm_D):
        B, S, D = q.shape
        ks = shift_k.shape[-1]
        k_pad = _pad(k, ((0, 0), (ks - 1, 0), (0, 0)))
        k_shift = torch.zeros_like(k)
        for t in range(ks):
            k_shift = k_shift + k_pad[:, t:t + S, :] * shift_k[:, ks - 1 - t][None, None, :]
        kv = k_shift * v
        L = 2 * S
        kv_pad = _pad(kv, ((0, 0), (0, S), (0, 0)))
        kf_pad = _pad(ssm_k, ((0, 0), (0, S)))
        kv_f = (lambda x, axes=(-2,-1): torch.fft.rfft2(x.float(), dim=axes))(kv_pad[:, None, :, :], axes=(1, 2))
        kf_f = (lambda x, axes=(-2,-1): torch.fft.rfft2(x.float(), dim=axes))(kf_pad[:, None, :], axes=(1, 2))
        kf_f = (lambda x, *d: x.permute(*d))(kf_f, 1, 2, 0)
        y_f = kv_f * kf_f[None, :, :, :]
        y = (lambda x, s, axes=(-2,-1): torch.fft.irfft2(x, s=s, dim=axes).to(torch.bfloat16))(y_f, (1, L), axes=(1, 2))[:, 0, :S, :]
        y = y + kv * ssm_D[None, None, :]
        return q * y

    def _B_ref(x, w1, w2):
        h = torch.einsum("bsd,df->bsf", x, w1)
        h = _silu(h)
        out = torch.einsum("bsf,fd->bsd", h, w2)
        return out

    x = A_q
    xn = _layernorm(x, axis=-1)
    s = _A_ref(xn, A_k, A_v, A_shift_k, A_ssm_k, A_ssm_D)
    g = _silu(_B_ref(xn, B_w1, B_w2))
    return x + s * g
```

```asm
; @launch grid=(256,1,1) block=(256,1,1) lds=163840
.amdgcn_target "amdgcn-amd-amdhsa--gfx950"
.text
.globl recurrent_scan__ssm_conv_h3__dense_activation_silu__prompt_kernel
.p2align 8
.type recurrent_scan__ssm_conv_h3__dense_activation_silu__prompt_kernel,@function
recurrent_scan__ssm_conv_h3__dense_activation_silu__prompt_kernel:
    s_cmp_ge_u32 s2, 256
    s_cbranch_scc1 L_end
    s_load_dwordx16 s[4:19], s[0:1], 0
    s_load_dwordx8 s[20:27], s[0:1], 64
    s_getpc_b64 s[52:53]
    s_and_b32 s3, s2, 0xf8
    s_lshl_b32 s3, s3, 7
    v_lshl_add_u32 v30, v0, 7, s3
    v_min_u32 v30, L_end-recurrent_scan__ssm_conv_h3__dense_activation_silu__prompt_kernel-64, v30
    s_mov_b64 exec, 255
    global_load_dword v247, v30, s[52:53]
    s_mov_b64 exec, -1
    v_lshrrev_b32 v26, 6, v0
    v_and_b32 v1, 63, v0
    s_nop 2
    v_readfirstlane_b32 s61, v26
    s_and_b32 s62, s2, 7
    s_lshr_b32 s63, s2, 3
    v_lshrrev_b32 v32, 5, v1
    v_and_b32 v33, 31, v1
    v_lshrrev_b32 v34, 3, v1
    v_and_b32 v35, 7, v1
    s_lshr_b32 s66, s63, 2
    s_and_b32 s95, s63, 3
    s_lshl_b32 s99, s61, 12
    s_lshl_b32 s64, s62, 18
    s_lshl_b32 s65, s63, 13
    s_add_u32 s64, s64, s65
    s_lshl_b32 s65, s61, 11
    s_add_u32 s64, s64, s65
    v_lshlrev_b32 v26, 10, v32
    v_lshl_add_u32 v26, v33, 4, v26
    v_add_u32 v219, s64, v26
    v_lshlrev_b32 v81, 10, v34
    v_lshl_add_u32 v81, v35, 4, v81
    s_lshl_b32 s64, s63, 16
    s_lshl_b32 s65, s61, 14
    s_add_u32 s64, s64, s65
    s_lshl_b32 s65, s62, 7
    s_add_u32 s64, s64, s65
    v_add_u32 v216, s64, v81
    v_subrev_u32 v217, 8192, v216
    s_lshl_b32 s64, s62, 9
    v_lshl_add_u32 v218, v33, 4, s64
    s_mul_i32 s3, s61, 5120
    s_add_u32 s3, s3, 131072
    s_movk_i32 s68, 8192
    s_waitcnt lgkmcnt(0)
    s_mov_b32 s28, s4
    s_and_b32 s29, s5, 0xffff
    s_mov_b32 s30, 2097152
    s_mov_b32 s31, 0x20000
    buffer_load_dwordx4 v[224:227], v219, s[28:31], 0 offen
    buffer_load_dwordx4 v[228:231], v219, s[28:31], 0 offen offset:512
    s_mov_b32 s32, s6
    s_and_b32 s33, s7, 0xffff
    s_mov_b32 s34, 2097152
    s_mov_b32 s35, 0x20000
    global_load_dwordx4 v[232:235], v218, s[10:11]
    s_mov_b32 m0, s3
    s_mov_b32 exec_lo, 0
    s_mov_b32 exec_hi, 0xffffff00
    buffer_load_dwordx4 v217, s[32:35], 0 offen nt lds
    s_mov_b64 exec, -1
    s_add_u32 m0, s3, 1024
    s_nop 0
    buffer_load_dwordx4 v216, s[32:35], 0 offen nt lds
    s_add_u32 m0, s3, 2048
    s_nop 0
    buffer_load_dwordx4 v216, s[32:35], s68 offen nt lds
    s_mov_b32 s36, s8
    s_and_b32 s37, s9, 0xffff
    s_mov_b32 s38, 2097152
    s_mov_b32 s39, 0x20000
    s_add_u32 m0, s3, 3072
    s_nop 0
    buffer_load_dwordx4 v216, s[36:39], 0 offen nt lds
    s_add_u32 m0, s3, 4096
    s_nop 0
    buffer_load_dwordx4 v216, s[36:39], s68 offen nt lds
    s_load_dword s60, s[26:27], 0
    s_lshl_b32 s64, s2, 2
    s_load_dword s72, s[14:15], s64
    s_lshr_b32 s97, s62, 1
    s_lshl_b32 s97, s97, 2
    s_add_u32 s97, s97, s95
    s_and_b32 s98, s62, 1
    s_mul_i32 s98, s98, 7
    s_add_u32 s98, s98, s66
    v_lshrrev_b32 v28, 4, v1
    v_xor_b32 v27, v35, v28
    v_lshlrev_b32 v26, 10, v34
    v_lshl_add_u32 v26, v27, 4, v26
    s_lshl_b32 s64, s97, 17
    s_lshl_b32 s65, s61, 15
    s_add_u32 s64, s64, s65
    v_add_u32 v2, s64, v26
    v_xor_b32 v3, 64, v2
    v_add_u32 v3, 7168, v3
    v_add_u32 v4, 14336, v2
    v_add_u32 v5, 14336, v3
    v_mul_u32_u24 v26, 3584, v28
    v_and_b32 v27, 15, v1
    v_lshlrev_b32 v29, 2, v28
    v_xor_b32 v27, v27, v29
    v_lshl_add_u32 v26, v27, 4, v26
    s_mul_i32 s64, s61, 57344
    s_lshl_b32 s65, s98, 8
    s_add_u32 s64, s64, s65
    v_add_u32 v6, s64, v26
    v_add_u32 v7, 13312, v6
    v_add_u32 v8, 26624, v6
    v_add_u32 v9, 39936, v6
    s_mov_b32 s44, s18
    s_and_b32 s45, s19, 0xffff
    s_mov_b32 s46, 1835008
    s_mov_b32 s47, 0x20000
    s_cmp_ge_u32 s63, 28
    s_cbranch_scc1 L_spare
    s_lshl_b32 s69, s95, 1
    s_add_u32 s69, s69, s66
    s_and_b32 s69, s69, 7
    s_lshl_b32 s70, s69, 7
    s_mul_i32 s71, s69, 229376
    s_add_u32 s69, s69, 1
    s_and_b32 s69, s69, 7
    s_add_u32 m0, s99, 0
    s_nop 0
    buffer_load_dwordx4 v2, s[28:31], s70 offen offset:0 lds
    buffer_load_dwordx4 v3, s[28:31], s70 offen offset:1024 lds
    s_mov_b32 s40, s12
    s_and_b32 s41, s13, 0xffff
    s_mov_b32 s42, 2097152
    s_mov_b32 s43, 0x20000
    s_lshl_b32 s64, s2, 13
    s_lshl_b32 s65, s61, 11
    s_add_u32 s64, s64, s65
    v_lshl_add_u32 v44, v1, 4, s64
    v_subrev_u32 v27, 8, v44
    v_and_b32 v28, 4095, v44
    v_mov_b32 v29, 0x7fffffff
    v_cmp_eq_u32 vcc, 0, v28
    s_nop 1
    v_cndmask_b32 v45, v27, v29, vcc
    s_mov_b32 s52, s22
    s_and_b32 s53, s23, 0xffff
    s_mov_b32 s54, 2097152
    s_mov_b32 s55, 0x20000
    s_mov_b32 s56, s26
    s_and_b32 s57, s27, 0xffff
    s_mov_b32 s58, 67108864
    s_mov_b32 s59, 0x20000
    s_mov_b32 s48, s20
    s_and_b32 s49, s21, 0xffff
    s_mov_b32 s50, 1835008
    s_mov_b32 s51, 0x20000
    s_lshr_b32 s67, s62, 1
    s_lshl_b32 s67, s67, 3
    s_and_b32 s64, s63, 7
    s_add_u32 s67, s67, s64
    s_and_b32 s66, s62, 1
    s_lshl_b32 s66, s66, 2
    s_lshr_b32 s65, s63, 3
    s_add_u32 s66, s66, s65
    s_lshr_b32 s17, s61, 1
    s_and_b32 s18, s61, 1
    s_mov_b32 s13, 114688
    s_mov_b32 s16, 32768
    v_and_b32 v30, 31, v1
    v_lshrrev_b32 v31, 5, v1
    v_bfe_u32 v26, v1, 1, 3
    v_xor_b32 v26, v26, v31
    v_lshlrev_b32 v26, 4, v26
    v_lshl_add_u32 v26, v30, 7, v26
    s_lshr_b32 s64, s61, 1
    s_lshl_b32 s64, s64, 13
    v_add_u32 v10, s64, v26
    v_xor_b32 v11, 32, v10
    v_xor_b32 v12, 64, v10
    v_xor_b32 v13, 96, v10
    v_bfe_u32 v26, v1, 2, 2
    v_lshl_add_u32 v27, v31, 3, v26
    v_lshlrev_b32 v27, 8, v27
    v_bfe_u32 v28, v1, 4, 1
    v_lshlrev_b32 v28, 1, v28
    v_bfe_u32 v29, v1, 1, 1
    v_or_b32 v28, v28, v29
    s_and_b32 s64, s61, 1
    s_lshl_b32 s64, s64, 3
    v_or_b32 v28, s64, v28
    v_lshlrev_b32 v26, 2, v26
    v_xor_b32 v28, v28, v26
    v_lshl_add_u32 v27, v28, 4, v27
    v_and_b32 v28, 1, v1
    v_lshl_add_u32 v27, v28, 3, v27
    s_and_b32 s64, s61, 2
    s_lshl_b32 s64, s64, 5
    v_xor_b32 v27, s64, v27
    v_mov_b32 v26, 0x3f803f80
    v_accvgpr_write_b32 a252, v26
    v_accvgpr_write_b32 a253, v26
    v_accvgpr_write_b32 a254, v26
    v_accvgpr_write_b32 a255, v26
    v_add_u32 v14, 16384, v27
    v_xor_b32 v15, 64, v14
    s_mul_i32 s64, s61, 5120
    s_add_u32 s64, s64, 131712
    v_lshlrev_b32 v40, 10, v32
    v_lshl_add_u32 v40, v33, 2, v40
    v_add_u32 v40, s64, v40
    v_add_u32 v41, 1024, v40
    v_add_u32 v42, 2432, v40
    s_lshl_b32 s64, s61, 1
    v_add_u32 v43, s64, v32
    v_and_b32 v18, 7, v33
    v_xor_b32 v43, v43, v18
    v_lshlrev_b32 v43, 4, v43
    v_lshl_add_u32 v43, v33, 8, v43
    v_add_u32 v43, 151552, v43
    v_lshrrev_b32 v18, 4, v1
    v_xor_b32 v18, v18, v35
    v_lshlrev_b32 v18, 4, v18
    v_lshl_add_u32 v18, v34, 7, v18
    s_lshl_b32 s64, s61, 11
    s_add_u32 s64, s64, 151552
    v_add_u32 v18, s64, v18
    v_xor_b32 v19, 64, v18
    v_lshlrev_b32 v63, 12, v34
    v_lshl_add_u32 v63, v35, 4, v63
    s_lshl_b32 s64, s62, 18
    s_lshl_b32 s65, s61, 16
    s_add_u32 s64, s64, s65
    s_lshl_b32 s65, s63, 7
    s_add_u32 s64, s64, s65
    s_add_u32 s64, s64, 1048576
    v_add_u32 v63, s64, v63
    s_mul_i32 s64, s17, 4608
    s_lshl_b32 s65, s18, 8
    s_add_u32 s64, s64, s65
    s_add_u32 s64, s64, 131584
    v_lshl_add_u32 v67, v1, 2, s64
    s_mov_b32 s64, 0
    s_lshl_b32 s73, s64, 12
    s_add_u32 s64, s64, 1
    s_cmp_ge_u32 s64, 7
    s_cselect_b32 s64, 0, s64
    s_lshl_b32 s74, s64, 12
    s_add_u32 s64, s64, 1
    s_cmp_ge_u32 s64, 7
    s_cselect_b32 s64, 0, s64
    s_lshl_b32 s75, s64, 12
    s_add_u32 s64, s64, 1
    s_cmp_ge_u32 s64, 7
    s_cselect_b32 s64, 0, s64
    s_lshl_b32 s76, s64, 12
    s_add_u32 s64, s64, 1
    s_cmp_ge_u32 s64, 7
    s_cselect_b32 s64, 0, s64
    s_lshl_b32 s77, s64, 12
    s_add_u32 s64, s64, 1
    s_cmp_ge_u32 s64, 7
    s_cselect_b32 s64, 0, s64
    s_lshl_b32 s78, s64, 12
    s_add_u32 s64, s64, 1
    s_cmp_ge_u32 s64, 7
    s_cselect_b32 s64, 0, s64
    s_lshl_b32 s79, s64, 12
    v_and_b32 v27, 16, v1
    v_lshrrev_b32 v27, 2, v27
    v_xor_b32 v27, v27, v35
    v_lshlrev_b32 v26, 10, v34
    v_lshl_add_u32 v26, v27, 4, v26
    s_mul_i32 s64, s61, 458752
    s_lshl_b32 s65, s66, 7
    s_add_u32 s64, s64, s65
    v_add_u32 v16, s64, v26
    v_add_u32 v17, 7168, v16
    v_add_u32 v20, 14336, v16
    v_add_u32 v24, 21504, v16
    v_lshlrev_b32 v26, 2, v32
    v_bfe_u32 v27, v1, 2, 2
    v_add_u32 v26, v26, v27
    v_lshlrev_b32 v26, 7, v26
    v_bfe_u32 v27, v1, 4, 1
    v_lshlrev_b32 v27, 1, v27
    v_bfe_u32 v28, v1, 1, 1
    v_or_b32 v27, v27, v28
    v_bfe_u32 v28, v1, 3, 1
    v_lshl_or_b32 v27, v28, 2, v27
    v_lshl_add_u32 v26, v27, 4, v26
    v_and_b32 v27, 1, v1
    v_lshl_add_u32 v26, v27, 3, v26
    s_lshl_b32 s19, s61, 13
    v_add_u32 v21, s19, v26
    v_xor_b32 v0, 64, v21
    s_lshl_b32 s64, s17, 10
    s_lshl_b32 s65, s97, 11
    s_add_u32 s64, s64, s65
    s_add_u32 s64, s64, 65536
    v_lshl_add_u32 v79, v34, 7, s64
    v_lshl_add_u32 v79, v35, 3, v79
    s_lshl_b32 s64, s61, 7
    s_add_u32 s64, s64, 159744
    v_lshl_add_u32 v76, v32, 6, s64
    v_xor_b32 v77, 256, v76
    s_mul_i32 s64, s97, 458752
    s_mul_i32 s65, s17, 231424
    s_add_u32 s64, s64, s65
    s_lshl_b32 s65, s98, 13
    s_add_u32 s64, s64, s65
    s_lshl_b32 s65, s18, 12
    s_add_u32 s64, s64, s65
    s_add_u32 s64, s64, 8388608
    v_lshl_add_u32 v38, v1, 4, s64
    v_xor_b32 v39, 2048, v38
    v_mov_b32 v61, 0xbfb8aa3b
    v_lshrrev_b32 v26, 2, v1
    v_min_u32 v27, 6, v26
    s_mul_i32 s64, s61, 7
    v_add_u32 v27, s64, v27
    v_and_b32 v28, 1, v27
    v_lshrrev_b32 v27, 1, v27
    v_cmp_le_u32 vcc, 7, v27
    s_nop 1
    v_cndmask_b32 v29, 0, 1, vcc
    v_mul_u32_u24 v30, 7, v29
    v_sub_u32 v27, v27, v30
    v_lshl_add_u32 v27, v27, 5, v29
    s_lshr_b32 s64, s67, 1
    s_and_b32 s65, s64, 3
    s_lshl_b32 s65, s65, 3
    s_lshr_b32 s64, s64, 2
    s_lshl_b32 s64, s64, 1
    s_add_u32 s64, s64, s65
    v_add_u32 v27, s64, v27
    v_lshlrev_b32 v27, 7, v27
    v_lshl_add_u32 v74, v28, 2, v27
    s_and_b32 s64, s67, 1
    s_lshl_b32 s64, s64, 3
    s_add_u32 s64, s64, 4112
    v_add_u32 v74, s64, v74
    v_lshrrev_b32 v27, 1, v26
    v_and_b32 v28, 1, v26
    s_lshl_b32 s64, s66, 5
    s_lshl_b32 s65, s61, 3
    s_add_u32 s64, s64, s65
    v_add_u32 v27, s64, v27
    v_lshlrev_b32 v27, 7, v27
    v_lshl_add_u32 v75, v28, 3, v27
    s_lshr_b32 s64, s67, 4
    s_lshl_b32 s64, s64, 2
    s_add_u32 s64, s64, 4128
    v_add_u32 v75, s64, v75
    s_lshr_b32 s64, s2, 5
    s_lshl_b32 s65, s18, 7
    s_add_u32 s64, s64, s65
    v_lshl_add_u32 v36, v26, 3, s64
    v_lshlrev_b32 v36, 7, v36
    s_and_b32 s64, s63, 3
    s_lshl_b32 s64, s64, 2
    s_add_u32 s64, s64, 4144
    v_add_u32 v36, s64, v36
    s_lshl_b32 s64, s2, 13
    s_lshl_b32 s65, s61, 11
    s_add_u32 s64, s64, s65
    s_add_u32 s64, s64, 1048576
    v_lshl_add_u32 v78, v1, 4, s64
    v_and_b32 v29, 15, v1
    v_lshlrev_b32 v86, 4, v29
    v_bfe_u32 v27, v1, 4, 1
    v_lshl_add_u32 v86, v27, 9, v86
    v_lshl_add_u32 v86, v32, 8, v86
    s_add_u32 s64, s64, 3145728
    v_add_u32 v86, s64, v86
    s_mul_i32 s4, s17, 4608
    s_lshl_b32 s65, s18, 11
    s_add_u32 s4, s4, s65
    s_add_u32 s4, s4, 132096
    s_lshl_b32 s64, s67, 10
    s_lshl_b32 s65, s61, 7
    s_add_u32 s64, s64, s65
    s_add_u32 s64, s64, 65536
    v_lshl_add_u32 v80, v34, 3, s64
    v_and_b32 v27, 1, v1
    v_lshl_add_u32 v80, v27, 9, v80
    s_lshl_b32 s7, s67, 16
    s_lshl_b32 s65, s61, 13
    s_add_u32 s7, s7, s65
    s_lshl_b32 s65, s66, 7
    s_add_u32 s7, s7, s65
    s_lshl_b32 s8, s61, 13
    s_add_u32 s8, s8, 32768
    v_lshlrev_b32 v82, 12, v34
    v_and_b32 v27, 3, v1
    v_lshl_add_u32 v82, v27, 4, v82
    v_bfe_u32 v27, v1, 2, 1
    v_lshl_add_u32 v82, v27, 8, v82
    s_lshr_b32 s64, s67, 2
    s_and_b32 s12, s67, 3
    s_lshl_b32 s9, s66, 18
    s_lshl_b32 s65, s61, 16
    s_add_u32 s9, s9, s65
    s_lshl_b32 s65, s64, 9
    s_add_u32 s9, s9, s65
    s_lshl_b32 s65, s12, 6
    s_add_u32 s9, s9, s65
    s_add_u32 s9, s9, 4194304
    s_mul_i32 s12, s61, 2080
    s_add_u32 s12, s12, 106496
    s_lshl_b32 s64, s67, 16
    s_lshl_b32 s65, s61, 13
    s_add_u32 s64, s64, s65
    s_lshl_b32 s65, s66, 7
    s_add_u32 s64, s64, s65
    v_add_u32 v87, s64, v81
    s_mul_i32 s64, s67, 229376
    s_mul_i32 s65, s61, 28672
    s_add_u32 s64, s64, s65
    s_add_u32 s64, s64, 8388608
    v_lshl_add_u32 v72, v1, 4, s64
    v_add_u32 v73, 114688, v72
    s_lshl_b32 s64, s61, 12
    s_add_u32 s64, s64, 140800
    v_lshl_add_u32 v84, v1, 4, s64
    v_xor_b32 v85, 4096, v84
    s_mul_i32 s64, s17, 16640
    s_add_u32 s64, s64, 98304
    v_lshrrev_b32 v27, 1, v1
    v_mul_u32_u24 v27, 4160, v27
    v_and_b32 v28, 1, v1
    v_lshl_add_u32 v27, v28, 4, v27
    v_add_u32 v66, s64, v27
    s_lshl_b32 s65, s18, 11
    s_add_u32 s65, s65, s64
    s_add_u32 s65, s65, 32
    v_lshl_add_u32 v83, v1, 4, s65
    v_lshrrev_b32 v26, 4, v1
    v_sub_u32 v28, 3, v29
    v_and_b32 v28, 3, v28
    v_add3_u32 v27, v29, v28, 9
    v_lshl_add_u32 v27, v32, 4, v27
    v_and_b32 v31, 1, v26
    v_lshlrev_b32 v64, 3, v31
    v_sub_u32 v27, v27, v64
    v_mul_u32_u24 v28, 4160, v28
    v_lshl_add_u32 v64, v27, 1, v28
    s_lshl_b32 s65, s18, 8
    s_add_u32 s64, s64, s65
    v_add_u32 v64, s64, v64
    v_sub_u32 v65, v29, v32
    v_lshlrev_b32 v65, 5, v65
    v_lshl_add_u32 v65, v31, 4, v65
    s_mul_i32 s64, s17, 4608
    s_sub_u32 s64, s64, s65
    s_add_u32 s64, s64, 131904
    v_add_u32 v65, s64, v65
    s_waitcnt lgkmcnt(0)
    s_mul_i32 s60, s60, 0x9E3779B1
    s_add_u32 s60, s60, 0x7F4A7C15
    v_mov_b32 v22, s60
    s_lshl_b32 s64, s2, 7
    s_lshl_b32 s65, s61, 2
    s_add_u32 s64, s64, s65
    s_add_u32 s64, s64, 4096
    v_mov_b32 v23, s64
    s_lshl_b32 s64, s17, 4
    s_lshr_b32 s72, s72, s64
    s_lshl_b32 s72, s72, 16
    v_lshlrev_b32 v68, 5, v29
    v_lshl_add_u32 v68, v32, 4, v68
    v_and_b32 v27, 1, v26
    v_xor_b32 v27, 1, v27
    v_lshl_add_u32 v68, v27, 3, v68
    v_add_u32 v68, s4, v68
    s_waitcnt vmcnt(8)
    v_lshlrev_b32 v88, 16, v224
    v_and_b32 v89, 0xffff0000, v224
    s_add_u32 m0, s99, 0
    s_nop 0
    buffer_load_dwordx4 v4, s[28:31], s70 offen offset:2048 lds
    v_lshlrev_b32 v90, 16, v225
    v_and_b32 v91, 0xffff0000, v225
    v_lshlrev_b32 v92, 16, v226
    v_and_b32 v93, 0xffff0000, v226
    v_lshlrev_b32 v94, 16, v227
    v_and_b32 v95, 0xffff0000, v227
    v_lshlrev_b32 v96, 16, v228
    v_and_b32 v97, 0xffff0000, v228
    v_lshlrev_b32 v98, 16, v229
    v_and_b32 v99, 0xffff0000, v229
    v_lshlrev_b32 v100, 16, v230
    v_and_b32 v101, 0xffff0000, v230
    v_lshlrev_b32 v102, 16, v231
    v_and_b32 v103, 0xffff0000, v231
    buffer_load_dwordx4 v5, s[28:31], s70 offen offset:3072 lds
    v_pk_add_f32 v[104:105], v[88:89], v[90:91]
    v_pk_add_f32 v[106:107], v[92:93], v[94:95]
    v_pk_add_f32 v[108:109], v[96:97], v[98:99]
    v_pk_add_f32 v[110:111], v[100:101], v[102:103]
    v_pk_add_f32 v[104:105], v[104:105], v[106:107]
    v_pk_add_f32 v[108:109], v[108:109], v[110:111]
    v_pk_add_f32 v[104:105], v[104:105], v[108:109]
    s_add_u32 m0, s99, 16384
    s_nop 0
    buffer_load_dwordx4 v6, s[44:47], s71 offen offset:0 lds
    v_add_f32 v104, v104, v105
    s_nop 1
    v_add_f32_dpp v104, v104, v104 quad_perm:[1,0,3,2] row_mask:0xf bank_mask:0xf bound_ctrl:1
    s_nop 1
    v_add_f32_dpp v104, v104, v104 quad_perm:[2,3,0,1] row_mask:0xf bank_mask:0xf bound_ctrl:1
    s_nop 1
    v_add_f32_dpp v104, v104, v104 row_half_mirror row_mask:0xf bank_mask:0xf bound_ctrl:1
    s_nop 1
    v_add_f32_dpp v104, v104, v104 row_mirror row_mask:0xf bank_mask:0xf bound_ctrl:1
    v_mov_b32 v106, v104
    s_nop 1
    v_permlane16_swap_b32 v104, v106
    buffer_load_dwordx4 v7, s[44:47], s71 offen offset:1024 lds
    v_add_f32 v104, v104, v106
    v_mul_f32 v104, 0x3b000000, v104
    v_pk_add_f32 v[88:89], v[88:89], v[104:105] op_sel_hi:[1,0] neg_lo:[0,1] neg_hi:[0,1]
    v_pk_add_f32 v[90:91], v[90:91], v[104:105] op_sel_hi:[1,0] neg_lo:[0,1] neg_hi:[0,1]
    v_pk_add_f32 v[92:93], v[92:93], v[104:105] op_sel_hi:[1,0] neg_lo:[0,1] neg_hi:[0,1]
    v_pk_add_f32 v[94:95], v[94:95], v[104:105] op_sel_hi:[1,0] neg_lo:[0,1] neg_hi:[0,1]
    v_pk_add_f32 v[96:97], v[96:97], v[104:105] op_sel_hi:[1,0] neg_lo:[0,1] neg_hi:[0,1]
    s_add_u32 m0, s99, 16384
    s_nop 0
    buffer_load_dwordx4 v8, s[44:47], s71 offen offset:2048 lds
    v_pk_add_f32 v[98:99], v[98:99], v[104:105] op_sel_hi:[1,0] neg_lo:[0,1] neg_hi:[0,1]
    v_pk_add_f32 v[100:101], v[100:101], v[104:105] op_sel_hi:[1,0] neg_lo:[0,1] neg_hi:[0,1]
    v_pk_add_f32 v[102:103], v[102:103], v[104:105] op_sel_hi:[1,0] neg_lo:[0,1] neg_hi:[0,1]
    v_pk_mul_f32 v[106:107], v[88:89], v[88:89]
    v_pk_mul_f32 v[108:109], v[90:91], v[90:91]
    v_pk_fma_f32 v[106:107], v[92:93], v[92:93], v[106:107]
    v_pk_fma_f32 v[108:109], v[94:95], v[94:95], v[108:109]
    buffer_load_dwordx4 v9, s[44:47], s71 offen offset:3072 lds
    v_pk_fma_f32 v[106:107], v[96:97], v[96:97], v[106:107]
    v_pk_fma_f32 v[108:109], v[98:99], v[98:99], v[108:109]
    v_pk_fma_f32 v[106:107], v[100:101], v[100:101], v[106:107]
    v_pk_fma_f32 v[108:109], v[102:103], v[102:103], v[108:109]
    v_pk_add_f32 v[106:107], v[106:107], v[108:109]
    v_add_f32 v106, v106, v107
    s_nop 1
    v_add_f32_dpp v106, v106, v106 quad_perm:[1,0,3,2] row_mask:0xf bank_mask:0xf bound_ctrl:1
    s_lshl_b32 s70, s69, 7
    s_mul_i32 s71, s69, 229376
    s_add_u32 s69, s69, 1
    s_and_b32 s69, s69, 7
    s_add_u32 m0, s99, 32768
    s_nop 0
    buffer_load_dwordx4 v2, s[28:31], s70 offen offset:0 lds
    v_add_f32_dpp v106, v106, v106 quad_perm:[2,3,0,1] row_mask:0xf bank_mask:0xf bound_ctrl:1
    s_nop 1
    v_add_f32_dpp v106, v106, v106 row_half_mirror row_mask:0xf bank_mask:0xf bound_ctrl:1
    s_nop 1
    v_add_f32_dpp v106, v106, v106 row_mirror row_mask:0xf bank_mask:0xf bound_ctrl:1
    v_mov_b32 v108, v106
    s_nop 1
    v_permlane16_swap_b32 v106, v108
    v_add_f32 v106, v106, v108
    v_mul_f32 v106, 0x3b000000, v106
    buffer_load_dwordx4 v3, s[28:31], s70 offen offset:1024 lds
    v_cvt_pk_bf16_f32 v106, v106, v106
    v_lshlrev_b32 v106, 16, v106
    v_add_f32 v106, 0x3727c5ac, v106
    v_cvt_pk_bf16_f32 v106, v106, v106
    v_lshlrev_b32 v106, 16, v106
    v_sqrt_f32 v106, v106
    v_mov_b32 v105, v22
    v_cvt_pk_bf16_f32 v104, v106, v104
    s_lshl_b32 s64, s62, 12
    s_lshl_b32 s65, s63, 7
    s_add_u32 s64, s64, s65
    s_lshl_b32 s65, s61, 4
    s_add_u32 s64, s64, s65
    s_add_u32 s64, s64, 65536
    v_lshl_add_u32 v29, v32, 3, s64
    s_mov_b32 exec_lo, 1
    s_mov_b32 exec_hi, 1
    buffer_store_dwordx2 v[104:105], v29, s[56:59], 0 offen sc1
    s_mov_b64 exec, -1
    s_waitcnt vmcnt(11)
    ds_read2_b32 v[236:237], v40 offset0:0 offset1:32
    ds_read2_b32 v[238:239], v40 offset0:64 offset1:96
    ds_read2_b32 v[240:241], v40 offset0:128 offset1:160
    ds_read2_b32 v[242:243], v40 offset0:192 offset1:224
    ds_read2_b32 v[244:245], v41 offset0:0 offset1:32
    ds_read_b32 v246, v41 offset:256
    ds_read2_b32 v[248:249], v42 offset0:0 offset1:32
    ds_read2_b32 v[250:251], v42 offset0:64 offset1:96
    ds_read2_b32 v[252:253], v42 offset0:128 offset1:160
    ds_read2_b32 v[254:255], v42 offset0:192 offset1:224
    v_lshlrev_b32 v112, 16, v232
    v_lshlrev_b32 v113, 16, v234
    v_and_b32 v114, 0xffff0000, v232
    v_and_b32 v115, 0xffff0000, v234
    v_lshlrev_b32 v116, 16, v233
    v_lshlrev_b32 v117, 16, v235
    v_and_b32 v118, 0xffff0000, v233
    v_and_b32 v119, 0xffff0000, v235
    s_waitcnt lgkmcnt(4)
    v_lshlrev_b32 v128, 16, v236
    v_and_b32 v129, 0xffff0000, v236
    s_add_u32 m0, s99, 32768
    s_nop 0
    buffer_load_dwordx4 v4, s[28:31], s70 offen offset:2048 lds
    v_lshlrev_b32 v130, 16, v237
    v_and_b32 v131, 0xffff0000, v237
    v_lshlrev_b32 v132, 16, v238
    v_and_b32 v133, 0xffff0000, v238
    v_lshlrev_b32 v134, 16, v239
    v_and_b32 v135, 0xffff0000, v239
    v_lshlrev_b32 v136, 16, v240
    v_and_b32 v137, 0xffff0000, v240
    v_lshlrev_b32 v138, 16, v241
    v_and_b32 v139, 0xffff0000, v241
    v_lshlrev_b32 v140, 16, v242
    v_and_b32 v141, 0xffff0000, v242
    v_lshlrev_b32 v142, 16, v243
    v_and_b32 v143, 0xffff0000, v243
    v_lshlrev_b32 v144, 16, v244
    v_and_b32 v145, 0xffff0000, v244
    v_lshlrev_b32 v146, 16, v245
    v_and_b32 v147, 0xffff0000, v245
    v_lshlrev_b32 v148, 16, v246
    v_and_b32 v149, 0xffff0000, v246
    v_pk_mul_f32 v[152:153], v[128:129], v[118:119]
    v_pk_mul_f32 v[154:155], v[130:131], v[118:119]
    v_pk_mul_f32 v[156:157], v[132:133], v[118:119]
    v_pk_mul_f32 v[158:159], v[134:135], v[118:119]
    v_pk_mul_f32 v[160:161], v[136:137], v[118:119]
    v_pk_mul_f32 v[162:163], v[138:139], v[118:119]
    v_pk_mul_f32 v[164:165], v[140:141], v[118:119]
    v_pk_mul_f32 v[166:167], v[142:143], v[118:119]
    v_cvt_pk_bf16_f32 v88, v152, v153
    v_cvt_pk_bf16_f32 v89, v154, v155
    buffer_load_dwordx4 v5, s[28:31], s70 offen offset:3072 lds
    v_cvt_pk_bf16_f32 v90, v156, v157
    v_cvt_pk_bf16_f32 v91, v158, v159
    v_cvt_pk_bf16_f32 v92, v160, v161
    v_cvt_pk_bf16_f32 v93, v162, v163
    v_cvt_pk_bf16_f32 v94, v164, v165
    v_cvt_pk_bf16_f32 v95, v166, v167
    v_lshlrev_b32 v152, 16, v88
    v_and_b32 v153, 0xffff0000, v88
    v_lshlrev_b32 v154, 16, v89
    v_and_b32 v155, 0xffff0000, v89
    v_lshlrev_b32 v156, 16, v90
    v_and_b32 v157, 0xffff0000, v90
    v_lshlrev_b32 v158, 16, v91
    v_and_b32 v159, 0xffff0000, v91
    v_lshlrev_b32 v160, 16, v92
    v_and_b32 v161, 0xffff0000, v92
    v_lshlrev_b32 v162, 16, v93
    v_and_b32 v163, 0xffff0000, v93
    v_lshlrev_b32 v164, 16, v94
    v_and_b32 v165, 0xffff0000, v94
    v_lshlrev_b32 v166, 16, v95
    v_and_b32 v167, 0xffff0000, v95
    v_pk_mul_f32 v[168:169], v[130:131], v[116:117]
    v_pk_mul_f32 v[170:171], v[132:133], v[116:117]
    v_pk_mul_f32 v[172:173], v[134:135], v[116:117]
    v_pk_mul_f32 v[174:175], v[136:137], v[116:117]
    v_pk_mul_f32 v[176:177], v[138:139], v[116:117]
    v_pk_mul_f32 v[178:179], v[140:141], v[116:117]
    s_add_u32 m0, s99, 49152
    s_nop 0
    buffer_load_dwordx4 v6, s[44:47], s71 offen offset:0 lds
    v_pk_mul_f32 v[180:181], v[142:143], v[116:117]
    v_pk_mul_f32 v[182:183], v[144:145], v[116:117]
    v_cvt_pk_bf16_f32 v88, v168, v169
    v_cvt_pk_bf16_f32 v89, v170, v171
    v_cvt_pk_bf16_f32 v90, v172, v173
    v_cvt_pk_bf16_f32 v91, v174, v175
    v_cvt_pk_bf16_f32 v92, v176, v177
    v_cvt_pk_bf16_f32 v93, v178, v179
    v_cvt_pk_bf16_f32 v94, v180, v181
    v_cvt_pk_bf16_f32 v95, v182, v183
    v_lshlrev_b32 v168, 16, v88
    v_and_b32 v169, 0xffff0000, v88
    v_lshlrev_b32 v170, 16, v89
    v_and_b32 v171, 0xffff0000, v89
    v_lshlrev_b32 v172, 16, v90
    v_and_b32 v173, 0xffff0000, v90
    v_lshlrev_b32 v174, 16, v91
    v_and_b32 v175, 0xffff0000, v91
    v_lshlrev_b32 v176, 16, v92
    v_and_b32 v177, 0xffff0000, v92
    v_lshlrev_b32 v178, 16, v93
    v_and_b32 v179, 0xffff0000, v93
    v_lshlrev_b32 v180, 16, v94
    v_and_b32 v181, 0xffff0000, v94
    v_lshlrev_b32 v182, 16, v95
    v_and_b32 v183, 0xffff0000, v95
    v_pk_add_f32 v[152:153], v[152:153], v[168:169]
    v_pk_add_f32 v[154:155], v[154:155], v[170:171]
    v_pk_add_f32 v[156:157], v[156:157], v[172:173]
    buffer_load_dwordx4 v7, s[44:47], s71 offen offset:1024 lds
    v_pk_add_f32 v[158:159], v[158:159], v[174:175]
    v_pk_add_f32 v[160:161], v[160:161], v[176:177]
    v_pk_add_f32 v[162:163], v[162:163], v[178:179]
    v_pk_add_f32 v[164:165], v[164:165], v[180:181]
    v_pk_add_f32 v[166:167], v[166:167], v[182:183]
    v_cvt_pk_bf16_f32 v88, v152, v153
    v_cvt_pk_bf16_f32 v89, v154, v155
    v_cvt_pk_bf16_f32 v90, v156, v157
    v_cvt_pk_bf16_f32 v91, v158, v159
    v_cvt_pk_bf16_f32 v92, v160, v161
    v_cvt_pk_bf16_f32 v93, v162, v163
    v_cvt_pk_bf16_f32 v94, v164, v165
    v_cvt_pk_bf16_f32 v95, v166, v167
    v_lshlrev_b32 v152, 16, v88
    v_and_b32 v153, 0xffff0000, v88
    v_lshlrev_b32 v154, 16, v89
    v_and_b32 v155, 0xffff0000, v89
    v_lshlrev_b32 v156, 16, v90
    v_and_b32 v157, 0xffff0000, v90
    v_lshlrev_b32 v158, 16, v91
    v_and_b32 v159, 0xffff0000, v91
    v_lshlrev_b32 v160, 16, v92
    v_and_b32 v161, 0xffff0000, v92
    v_lshlrev_b32 v162, 16, v93
    v_and_b32 v163, 0xffff0000, v93
    v_lshlrev_b32 v164, 16, v94
    v_and_b32 v165, 0xffff0000, v94
    s_add_u32 m0, s99, 49152
    s_nop 0
    buffer_load_dwordx4 v8, s[44:47], s71 offen offset:2048 lds
    v_lshlrev_b32 v166, 16, v95
    v_and_b32 v167, 0xffff0000, v95
    v_pk_mul_f32 v[168:169], v[132:133], v[114:115]
    v_pk_mul_f32 v[170:171], v[134:135], v[114:115]
    v_pk_mul_f32 v[172:173], v[136:137], v[114:115]
    v_pk_mul_f32 v[174:175], v[138:139], v[114:115]
    v_pk_mul_f32 v[176:177], v[140:141], v[114:115]
    v_pk_mul_f32 v[178:179], v[142:143], v[114:115]
    v_pk_mul_f32 v[180:181], v[144:145], v[114:115]
    v_pk_mul_f32 v[182:183], v[146:147], v[114:115]
    v_cvt_pk_bf16_f32 v88, v168, v169
    v_cvt_pk_bf16_f32 v89, v170, v171
    v_cvt_pk_bf16_f32 v90, v172, v173
    v_cvt_pk_bf16_f32 v91, v174, v175
    v_cvt_pk_bf16_f32 v92, v176, v177
    v_cvt_pk_bf16_f32 v93, v178, v179
    v_cvt_pk_bf16_f32 v94, v180, v181
    v_cvt_pk_bf16_f32 v95, v182, v183
    v_lshlrev_b32 v168, 16, v88
    v_and_b32 v169, 0xffff0000, v88
    v_lshlrev_b32 v170, 16, v89
    v_and_b32 v171, 0xffff0000, v89
    v_lshlrev_b32 v172, 16, v90
    v_and_b32 v173, 0xffff0000, v90
    v_lshlrev_b32 v174, 16, v91
    v_and_b32 v175, 0xffff0000, v91
    buffer_load_dwordx4 v9, s[44:47], s71 offen offset:3072 lds
    v_lshlrev_b32 v176, 16, v92
    v_and_b32 v177, 0xffff0000, v92
    v_lshlrev_b32 v178, 16, v93
    v_and_b32 v179, 0xffff0000, v93
    v_lshlrev_b32 v180, 16, v94
    v_and_b32 v181, 0xffff0000, v94
    v_lshlrev_b32 v182, 16, v95
    v_and_b32 v183, 0xffff0000, v95
    v_pk_add_f32 v[152:153], v[152:153], v[168:169]
    v_pk_add_f32 v[154:155], v[154:155], v[170:171]
    v_pk_add_f32 v[156:157], v[156:157], v[172:173]
    v_pk_add_f32 v[158:159], v[158:159], v[174:175]
    v_pk_add_f32 v[160:161], v[160:161], v[176:177]
    v_pk_add_f32 v[162:163], v[162:163], v[178:179]
    v_pk_add_f32 v[164:165], v[164:165], v[180:181]
    v_pk_add_f32 v[166:167], v[166:167], v[182:183]
    v_cvt_pk_bf16_f32 v88, v152, v153
    v_cvt_pk_bf16_f32 v89, v154, v155
    v_cvt_pk_bf16_f32 v90, v156, v157
    v_cvt_pk_bf16_f32 v91, v158, v159
    v_cvt_pk_bf16_f32 v92, v160, v161
    v_cvt_pk_bf16_f32 v93, v162, v163
    v_cvt_pk_bf16_f32 v94, v164, v165
    v_cvt_pk_bf16_f32 v95, v166, v167
    s_lshl_b32 s70, s69, 7
    s_mul_i32 s71, s69, 229376
    s_add_u32 s69, s69, 1
    s_and_b32 s69, s69, 7
    s_add_u32 m0, s99, 65536
    s_nop 0
    buffer_load_dwordx4 v2, s[28:31], s70 offen offset:0 lds
    v_lshlrev_b32 v152, 16, v88
    v_and_b32 v153, 0xffff0000, v88
    v_lshlrev_b32 v154, 16, v89
    v_and_b32 v155, 0xffff0000, v89
    v_lshlrev_b32 v156, 16, v90
    v_and_b32 v157, 0xffff0000, v90
    v_lshlrev_b32 v158, 16, v91
    v_and_b32 v159, 0xffff0000, v91
    v_lshlrev_b32 v160, 16, v92
    v_and_b32 v161, 0xffff0000, v92
    v_lshlrev_b32 v162, 16, v93
    v_and_b32 v163, 0xffff0000, v93
    v_lshlrev_b32 v164, 16, v94
    v_and_b32 v165, 0xffff0000, v94
    v_lshlrev_b32 v166, 16, v95
    v_and_b32 v167, 0xffff0000, v95
    v_pk_mul_f32 v[168:169], v[134:135], v[112:113]
    v_pk_mul_f32 v[170:171], v[136:137], v[112:113]
    v_pk_mul_f32 v[172:173], v[138:139], v[112:113]
    v_pk_mul_f32 v[174:175], v[140:141], v[112:113]
    v_pk_mul_f32 v[176:177], v[142:143], v[112:113]
    v_pk_mul_f32 v[178:179], v[144:145], v[112:113]
    v_pk_mul_f32 v[180:181], v[146:147], v[112:113]
    v_pk_mul_f32 v[182:183], v[148:149], v[112:113]
    v_cvt_pk_bf16_f32 v88, v168, v169
    v_cvt_pk_bf16_f32 v89, v170, v171
    v_cvt_pk_bf16_f32 v90, v172, v173
    v_cvt_pk_bf16_f32 v91, v174, v175
    buffer_load_dwordx4 v3, s[28:31], s70 offen offset:1024 lds
    v_cvt_pk_bf16_f32 v92, v176, v177
    v_cvt_pk_bf16_f32 v93, v178, v179
    v_cvt_pk_bf16_f32 v94, v180, v181
    v_cvt_pk_bf16_f32 v95, v182, v183
    v_lshlrev_b32 v168, 16, v88
    v_and_b32 v169, 0xffff0000, v88
    v_lshlrev_b32 v170, 16, v89
    v_and_b32 v171, 0xffff0000, v89
    v_lshlrev_b32 v172, 16, v90
    v_and_b32 v173, 0xffff0000, v90
    v_lshlrev_b32 v174, 16, v91
    v_and_b32 v175, 0xffff0000, v91
    v_lshlrev_b32 v176, 16, v92
    v_and_b32 v177, 0xffff0000, v92
    v_lshlrev_b32 v178, 16, v93
    v_and_b32 v179, 0xffff0000, v93
    v_lshlrev_b32 v180, 16, v94
    v_and_b32 v181, 0xffff0000, v94
    v_lshlrev_b32 v182, 16, v95
    v_and_b32 v183, 0xffff0000, v95
    v_pk_add_f32 v[152:153], v[152:153], v[168:169]
    v_pk_add_f32 v[154:155], v[154:155], v[170:171]
    v_pk_add_f32 v[156:157], v[156:157], v[172:173]
    v_pk_add_f32 v[158:159], v[158:159], v[174:175]
    v_pk_add_f32 v[160:161], v[160:161], v[176:177]
    v_pk_add_f32 v[162:163], v[162:163], v[178:179]
    v_pk_add_f32 v[164:165], v[164:165], v[180:181]
    v_pk_add_f32 v[166:167], v[166:167], v[182:183]
    v_cvt_pk_bf16_f32 v88, v152, v153
    s_add_u32 m0, s99, 65536
    s_nop 0
    buffer_load_dwordx4 v4, s[28:31], s70 offen offset:2048 lds
    v_cvt_pk_bf16_f32 v89, v154, v155
    v_cvt_pk_bf16_f32 v90, v156, v157
    v_cvt_pk_bf16_f32 v91, v158, v159
    v_cvt_pk_bf16_f32 v92, v160, v161
    v_cvt_pk_bf16_f32 v93, v162, v163
    v_cvt_pk_bf16_f32 v94, v164, v165
    v_cvt_pk_bf16_f32 v95, v166, v167
    v_lshlrev_b32 v152, 16, v88
    v_and_b32 v153, 0xffff0000, v88
    v_lshlrev_b32 v154, 16, v89
    v_and_b32 v155, 0xffff0000, v89
    v_lshlrev_b32 v156, 16, v90
    v_and_b32 v157, 0xffff0000, v90
    v_lshlrev_b32 v158, 16, v91
    v_and_b32 v159, 0xffff0000, v91
    v_lshlrev_b32 v160, 16, v92
    v_and_b32 v161, 0xffff0000, v92
    v_lshlrev_b32 v162, 16, v93
    v_and_b32 v163, 0xffff0000, v93
    v_lshlrev_b32 v164, 16, v94
    v_and_b32 v165, 0xffff0000, v94
    v_lshlrev_b32 v166, 16, v95
    v_and_b32 v167, 0xffff0000, v95
    s_waitcnt lgkmcnt(0)
    v_lshlrev_b32 v128, 16, v248
    v_and_b32 v129, 0xffff0000, v248
    v_lshlrev_b32 v130, 16, v249
    v_and_b32 v131, 0xffff0000, v249
    v_lshlrev_b32 v132, 16, v250
    v_and_b32 v133, 0xffff0000, v250
    v_lshlrev_b32 v134, 16, v251
    v_and_b32 v135, 0xffff0000, v251
    buffer_load_dwordx4 v5, s[28:31], s70 offen offset:3072 lds
    v_lshlrev_b32 v136, 16, v252
    v_and_b32 v137, 0xffff0000, v252
    v_lshlrev_b32 v138, 16, v253
    v_and_b32 v139, 0xffff0000, v253
    v_lshlrev_b32 v140, 16, v254
    v_and_b32 v141, 0xffff0000, v254
    v_lshlrev_b32 v142, 16, v255
    v_and_b32 v143, 0xffff0000, v255
    v_pk_mul_f32 v[152:153], v[152:153], v[128:129]
    v_pk_mul_f32 v[154:155], v[154:155], v[130:131]
    v_pk_mul_f32 v[156:157], v[156:157], v[132:133]
    v_pk_mul_f32 v[158:159], v[158:159], v[134:135]
    v_pk_mul_f32 v[160:161], v[160:161], v[136:137]
    v_pk_mul_f32 v[162:163], v[162:163], v[138:139]
    v_pk_mul_f32 v[164:165], v[164:165], v[140:141]
    v_pk_mul_f32 v[166:167], v[166:167], v[142:143]
    v_cvt_pk_bf16_f32 v112, v166, v164
    v_cvt_pk_bf16_f32 v113, v162, v160
    v_cvt_pk_bf16_f32 v114, v158, v156
    v_cvt_pk_bf16_f32 v115, v154, v152
    v_cvt_pk_bf16_f32 v116, v167, v165
    v_cvt_pk_bf16_f32 v117, v163, v161
    v_cvt_pk_bf16_f32 v118, v159, v157
    v_cvt_pk_bf16_f32 v119, v155, v153
    ds_write_b128 v43, v[112:115]
    ds_write_b128 v43, v[116:119] offset:128
    s_waitcnt vmcnt(13) lgkmcnt(0)
    s_barrier
    ds_read_b64_tr_b16 v[184:185], v14 offset:0
    ds_read_b64_tr_b16 v[186:187], v14 offset:1024
    ds_read_b128 v[192:195], v10 offset:0
    ds_read_b64_tr_b16 v[188:189], v15 offset:0
    ds_read_b64_tr_b16 v[190:191], v15 offset:1024
    ds_read_b128 v[196:199], v10 offset:4096
    s_waitcnt lgkmcnt(0)
    v_mfma_f32_32x32x16_bf16 v[88:103], v[184:187], v[192:195], 0
    ds_read_b64_tr_b16 v[200:201], v14 offset:4096
    ds_read_b64_tr_b16 v[202:203], v14 offset:5120
    ds_read_b128 v[208:211], v11 offset:0
    v_mfma_f32_32x32x16_bf16 v[120:135], v[188:191], v[192:195], 0
    ds_read_b64_tr_b16 v[204:205], v15 offset:4096
    ds_read_b64_tr_b16 v[206:207], v15 offset:5120
    ds_read_b128 v[212:215], v11 offset:4096
    v_mfma_f32_32x32x16_bf16 v[152:167], v[184:187], a[252:255], 0
    ds_read_b128 v[232:235], v18
    ds_read_b128 v[236:239], v19 offset:1024
    s_add_u32 m0, s99, 81920
    s_nop 0
    buffer_load_dwordx4 v6, s[44:47], s71 offen offset:0 lds
    v_mfma_f32_32x32x16_bf16 v[104:119], v[184:187], v[196:199], 0
    buffer_load_dwordx4 v7, s[44:47], s71 offen offset:1024 lds
    s_waitcnt lgkmcnt(1)
    buffer_store_dwordx4 v[232:235], v63, s[56:59], 0 offen sc1
    v_mfma_f32_32x32x16_bf16 v[136:151], v[188:191], v[196:199], 0
    s_waitcnt lgkmcnt(0)
    buffer_store_dwordx4 v[236:239], v63, s[56:59], s16 offen sc1
    s_add_u32 m0, s99, 81920
    s_nop 0
    buffer_load_dwordx4 v8, s[44:47], s71 offen offset:2048 lds
    v_mfma_f32_32x32x16_bf16 v[88:103], v[200:203], v[208:211], v[88:103]
    ds_read_b64_tr_b16 v[184:185], v14 offset:8192
    ds_read_b64_tr_b16 v[186:187], v14 offset:9216
    ds_read_b128 v[192:195], v12 offset:0
    v_mfma_f32_32x32x16_bf16 v[120:135], v[204:207], v[208:211], v[120:135]
    ds_read_b64_tr_b16 v[188:189], v15 offset:8192
    ds_read_b64_tr_b16 v[190:191], v15 offset:9216
    ds_read_b128 v[196:199], v12 offset:4096
    v_mfma_f32_32x32x16_bf16 v[152:167], v[200:203], a[252:255], v[152:167]
    buffer_load_dwordx4 v9, s[44:47], s71 offen offset:3072 lds
    s_lshl_b32 s70, s69, 7
    s_mul_i32 s71, s69, 229376
    v_mfma_f32_32x32x16_bf16 v[104:119], v[200:203], v[212:215], v[104:119]
    s_add_u32 s69, s69, 1
    s_and_b32 s69, s69, 7
    v_mfma_f32_32x32x16_bf16 v[136:151], v[204:207], v[212:215], v[136:151]
    s_add_u32 m0, s99, 98304
    s_nop 0
    buffer_load_dwordx4 v2, s[28:31], s70 offen offset:0 lds
    buffer_load_dwordx4 v3, s[28:31], s70 offen offset:1024 lds
    s_waitcnt lgkmcnt(0)
    v_mfma_f32_32x32x16_bf16 v[88:103], v[184:187], v[192:195], v[88:103]
    ds_read_b64_tr_b16 v[200:201], v14 offset:12288
    ds_read_b64_tr_b16 v[202:203], v14 offset:13312
    ds_read_b128 v[208:211], v13 offset:0
    v_mfma_f32_32x32x16_bf16 v[120:135], v[188:191], v[192:195], v[120:135]
    ds_read_b64_tr_b16 v[204:205], v15 offset:12288
    ds_read_b64_tr_b16 v[206:207], v15 offset:13312
    ds_read_b128 v[212:215], v13 offset:4096
    v_mfma_f32_32x32x16_bf16 v[152:167], v[184:187], a[252:255], v[152:167]
    s_add_u32 m0, s99, 98304
    s_nop 0
    buffer_load_dwordx4 v4, s[28:31], s70 offen offset:2048 lds
    buffer_load_dwordx4 v5, s[28:31], s70 offen offset:3072 lds
    v_mfma_f32_32x32x16_bf16 v[104:119], v[184:187], v[196:199], v[104:119]
    s_add_u32 m0, s99, 114688
    s_nop 0
    buffer_load_dwordx4 v6, s[44:47], s71 offen offset:0 lds
    buffer_load_dwordx4 v7, s[44:47], s71 offen offset:1024 lds
    v_mfma_f32_32x32x16_bf16 v[136:151], v[188:191], v[196:199], v[136:151]
    s_add_u32 m0, s99, 114688
    s_nop 0
    buffer_load_dwordx4 v8, s[44:47], s71 offen offset:2048 lds
    buffer_load_dwordx4 v9, s[44:47], s71 offen offset:3072 lds
    s_waitcnt lgkmcnt(0)
    s_waitcnt vmcnt(18)
    s_barrier
    v_mfma_f32_32x32x16_bf16 v[88:103], v[200:203], v[208:211], v[88:103]
    ds_read_b64_tr_b16 v[184:185], v14 offset:32768
    ds_read_b64_tr_b16 v[186:187], v14 offset:33792
    ds_read_b128 v[192:195], v10 offset:32768
    v_mfma_f32_32x32x16_bf16 v[120:135], v[204:207], v[208:211], v[120:135]
    ds_read_b64_tr_b16 v[188:189], v15 offset:32768
    ds_read_b64_tr_b16 v[190:191], v15 offset:33792
    ds_read_b128 v[196:199], v10 offset:36864
    v_mfma_f32_32x32x16_bf16 v[152:167], v[200:203], a[252:255], v[152:167]
    v_mfma_f32_32x32x16_bf16 v[104:119], v[200:203], v[212:215], v[104:119]
    v_mfma_f32_32x32x16_bf16 v[136:151], v[204:207], v[212:215], v[136:151]
    s_waitcnt lgkmcnt(0)
    v_mfma_f32_32x32x16_bf16 v[88:103], v[184:187], v[192:195], v[88:103]
    ds_read_b64_tr_b16 v[200:201], v14 offset:36864
    ds_read_b64_tr_b16 v[202:203], v14 offset:37888
    ds_read_b128 v[208:211], v11 offset:32768
    v_mfma_f32_32x32x16_bf16 v[120:135], v[188:191], v[192:195], v[120:135]
    ds_read_b64_tr_b16 v[204:205], v15 offset:36864
    ds_read_b64_tr_b16 v[206:207], v15 offset:37888
    ds_read_b128 v[212:215], v11 offset:36864
    v_mfma_f32_32x32x16_bf16 v[152:167], v[184:187], a[252:255], v[152:167]
    s_lshl_b32 s70, s69, 7
    s_mul_i32 s71, s69, 229376
    v_mfma_f32_32x32x16_bf16 v[104:119], v[184:187], v[196:199], v[104:119]
    s_add_u32 s69, s69, 1
    s_and_b32 s69, s69, 7
    v_mfma_f32_32x32x16_bf16 v[136:151], v[188:191], v[196:199], v[136:151]
    s_add_u32 m0, s99, 0
    s_nop 0
    buffer_load_dwordx4 v2, s[28:31], s70 offen offset:0 lds
    s_waitcnt lgkmcnt(0)
    v_mfma_f32_32x32x16_bf16 v[88:103], v[200:203], v[208:211], v[88:103]
    ds_read_b64_tr_b16 v[184:185], v14 offset:40960
    ds_read_b64_tr_b16 v[186:187], v14 offset:41984
    ds_read_b128 v[192:195], v12 offset:32768
    v_mfma_f32_32x32x16_bf16 v[120:135], v[204:207], v[208:211], v[120:135]
    ds_read_b64_tr_b16 v[188:189], v15 offset:40960
    ds_read_b64_tr_b16 v[190:191], v15 offset:41984
    ds_read_b128 v[196:199], v12 offset:36864
    v_mfma_f32_32x32x16_bf16 v[152:167], v[200:203], a[252:255], v[152:167]
    buffer_load_dwordx4 v3, s[28:31], s70 offen offset:1024 lds
    s_add_u32 m0, s99, 0
    s_nop 0
    buffer_load_dwordx4 v4, s[28:31], s70 offen offset:2048 lds
    v_mfma_f32_32x32x16_bf16 v[104:119], v[200:203], v[212:215], v[104:119]
    buffer_load_dwordx4 v5, s[28:31], s70 offen offset:3072 lds
    v_mfma_f32_32x32x16_bf16 v[136:151], v[204:207], v[212:215], v[136:151]
    s_add_u32 m0, s99, 16384
    s_nop 0
    buffer_load_dwordx4 v6, s[44:47], s71 offen offset:0 lds
    s_waitcnt lgkmcnt(0)
    v_mfma_f32_32x32x16_bf16 v[88:103], v[184:187], v[192:195], v[88:103]
    ds_read_b64_tr_b16 v[200:201], v14 offset:45056
    ds_read_b64_tr_b16 v[202:203], v14 offset:46080
    ds_read_b128 v[208:211], v13 offset:32768
    v_mfma_f32_32x32x16_bf16 v[120:135], v[188:191], v[192:195], v[120:135]
    ds_read_b64_tr_b16 v[204:205], v15 offset:45056
    ds_read_b64_tr_b16 v[206:207], v15 offset:46080
    ds_read_b128 v[212:215], v13 offset:36864
    v_mfma_f32_32x32x16_bf16 v[152:167], v[184:187], a[252:255], v[152:167]
    buffer_load_dwordx4 v7, s[44:47], s71 offen offset:1024 lds
    s_add_u32 m0, s99, 16384
    s_nop 0
    buffer_load_dwordx4 v8, s[44:47], s71 offen offset:2048 lds
    v_mfma_f32_32x32x16_bf16 v[104:119], v[184:187], v[196:199], v[104:119]
    buffer_load_dwordx4 v9, s[44:47], s71 offen offset:3072 lds
    v_mfma_f32_32x32x16_bf16 v[136:151], v[188:191], v[196:199], v[136:151]
    s_waitcnt vmcnt(18)
    s_mov_b64 exec, 1
    buffer_store_dword v22, v23, s[56:59], 0 offen offset:48 sc1
    s_mov_b64 exec, -1
    s_waitcnt lgkmcnt(0)
    s_waitcnt vmcnt(17)
    s_barrier
    v_mfma_f32_32x32x16_bf16 v[88:103], v[200:203], v[208:211], v[88:103]
    v_xor_b32 v10, 65536, v10
    v_xor_b32 v11, 65536, v11
    v_xor_b32 v12, 65536, v12
    v_xor_b32 v13, 65536, v13
    v_xor_b32 v14, 65536, v14
    v_xor_b32 v15, 65536, v15
    v_mfma_f32_32x32x16_bf16 v[120:135], v[204:207], v[208:211], v[120:135]
    ds_read_b64_tr_b16 v[184:185], v14 offset:0
    ds_read_b64_tr_b16 v[186:187], v14 offset:1024
    ds_read_b128 v[192:195], v10 offset:0
    v_mfma_f32_32x32x16_bf16 v[152:167], v[200:203], a[252:255], v[152:167]
    ds_read_b64_tr_b16 v[188:189], v15 offset:0
    ds_read_b64_tr_b16 v[190:191], v15 offset:1024
    ds_read_b128 v[196:199], v10 offset:4096
    v_mfma_f32_32x32x16_bf16 v[104:119], v[200:203], v[212:215], v[104:119]
    v_mfma_f32_32x32x16_bf16 v[136:151], v[204:207], v[212:215], v[136:151]
    s_waitcnt lgkmcnt(0)
    v_mfma_f32_32x32x16_bf16 v[88:103], v[184:187], v[192:195], v[88:103]
    ds_read_b64_tr_b16 v[200:201], v14 offset:4096
    ds_read_b64_tr_b16 v[202:203], v14 offset:5120
    ds_read_b128 v[208:211], v11 offset:0
    v_mfma_f32_32x32x16_bf16 v[120:135], v[188:191], v[192:195], v[120:135]
    ds_read_b64_tr_b16 v[204:205], v15 offset:4096
    ds_read_b64_tr_b16 v[206:207], v15 offset:5120
    ds_read_b128 v[212:215], v11 offset:4096
    v_mfma_f32_32x32x16_bf16 v[152:167], v[184:187], a[252:255], v[152:167]
    s_lshl_b32 s70, s69, 7
    s_mul_i32 s71, s69, 229376
    v_mfma_f32_32x32x16_bf16 v[104:119], v[184:187], v[196:199], v[104:119]
    s_add_u32 s69, s69, 1
    s_and_b32 s69, s69, 7
    v_mfma_f32_32x32x16_bf16 v[136:151], v[188:191], v[196:199], v[136:151]
    s_add_u32 m0, s99, 32768
    s_nop 0
    buffer_load_dwordx4 v2, s[28:31], s70 offen offset:0 lds
    buffer_load_dwordx4 v3, s[28:31], s70 offen offset:1024 lds
    s_waitcnt lgkmcnt(0)
    v_mfma_f32_32x32x16_bf16 v[88:103], v[200:203], v[208:211], v[88:103]
    ds_read_b64_tr_b16 v[184:185], v14 offset:8192
    ds_read_b64_tr_b16 v[186:187], v14 offset:9216
    ds_read_b128 v[192:195], v12 offset:0
    v_mfma_f32_32x32x16_bf16 v[120:135], v[204:207], v[208:211], v[120:135]
    ds_read_b64_tr_b16 v[188:189], v15 offset:8192
    ds_read_b64_tr_b16 v[190:191], v15 offset:9216
    ds_read_b128 v[196:199], v12 offset:4096
    v_mfma_f32_32x32x16_bf16 v[152:167], v[200:203], a[252:255], v[152:167]
    s_add_u32 m0, s99, 32768
    s_nop 0
    buffer_load_dwordx4 v4, s[28:31], s70 offen offset:2048 lds
    buffer_load_dwordx4 v5, s[28:31], s70 offen offset:3072 lds
    v_mfma_f32_32x32x16_bf16 v[104:119], v[200:203], v[212:215], v[104:119]
    s_add_u32 m0, s99, 49152
    s_nop 0
    buffer_load_dwordx4 v6, s[44:47], s71 offen offset:0 lds
    buffer_load_dwordx4 v7, s[44:47], s71 offen offset:1024 lds
    v_mfma_f32_32x32x16_bf16 v[136:151], v[204:207], v[212:215], v[136:151]
    s_add_u32 m0, s99, 49152
    s_nop 0
    buffer_load_dwordx4 v8, s[44:47], s71 offen offset:2048 lds
    s_waitcnt lgkmcnt(0)
    v_mfma_f32_32x32x16_bf16 v[88:103], v[184:187], v[192:195], v[88:103]
    ds_read_b64_tr_b16 v[200:201], v14 offset:12288
    ds_read_b64_tr_b16 v[202:203], v14 offset:13312
    ds_read_b128 v[208:211], v13 offset:0
    v_mfma_f32_32x32x16_bf16 v[120:135], v[188:191], v[192:195], v[120:135]
    ds_read_b64_tr_b16 v[204:205], v15 offset:12288
    ds_read_b64_tr_b16 v[206:207], v15 offset:13312
    ds_read_b128 v[212:215], v13 offset:4096
    v_mfma_f32_32x32x16_bf16 v[152:167], v[184:187], a[252:255], v[152:167]
    buffer_load_dwordx4 v9, s[44:47], s71 offen offset:3072 lds
    buffer_load_dwordx4 v[46:49], v44, s[40:43], 0 offen nt
    v_mfma_f32_32x32x16_bf16 v[104:119], v[184:187], v[196:199], v[104:119]
    buffer_load_dwordx4 v[52:55], v44, s[40:43], 0 offen offset:1024 nt
    buffer_load_dwordx2 v[50:51], v44, s[40:43], 0 offen offset:1016 nt
    v_mfma_f32_32x32x16_bf16 v[136:151], v[188:191], v[196:199], v[136:151]
    buffer_load_dwordx2 v[44:45], v45, s[40:43], 0 offen nt
    s_waitcnt lgkmcnt(0)
    s_waitcnt vmcnt(21)
    s_barrier
    v_mfma_f32_32x32x16_bf16 v[88:103], v[200:203], v[208:211], v[88:103]
    ds_read_b64_tr_b16 v[184:185], v14 offset:32768
    ds_read_b64_tr_b16 v[186:187], v14 offset:33792
    ds_read_b128 v[192:195], v10 offset:32768
    v_mfma_f32_32x32x16_bf16 v[120:135], v[204:207], v[208:211], v[120:135]
    ds_read_b64_tr_b16 v[188:189], v15 offset:32768
    ds_read_b64_tr_b16 v[190:191], v15 offset:33792
    ds_read_b128 v[196:199], v10 offset:36864
    v_mfma_f32_32x32x16_bf16 v[152:167], v[200:203], a[252:255], v[152:167]
    v_mfma_f32_32x32x16_bf16 v[104:119], v[200:203], v[212:215], v[104:119]
    v_mfma_f32_32x32x16_bf16 v[136:151], v[204:207], v[212:215], v[136:151]
    s_waitcnt lgkmcnt(0)
    v_mfma_f32_32x32x16_bf16 v[88:103], v[184:187], v[192:195], v[88:103]
    ds_read_b64_tr_b16 v[200:201], v14 offset:36864
    ds_read_b64_tr_b16 v[202:203], v14 offset:37888
    ds_read_b128 v[208:211], v11 offset:32768
    v_mfma_f32_32x32x16_bf16 v[120:135], v[188:191], v[192:195], v[120:135]
    ds_read_b64_tr_b16 v[204:205], v15 offset:36864
    ds_read_b64_tr_b16 v[206:207], v15 offset:37888
    ds_read_b128 v[212:215], v11 offset:36864
    v_mfma_f32_32x32x16_bf16 v[152:167], v[184:187], a[252:255], v[152:167]
    s_lshl_b32 s70, s69, 7
    s_mul_i32 s71, s69, 229376
    v_mfma_f32_32x32x16_bf16 v[104:119], v[184:187], v[196:199], v[104:119]
    s_add_u32 s69, s69, 1
    s_and_b32 s69, s69, 7
    v_mfma_f32_32x32x16_bf16 v[136:151], v[188:191], v[196:199], v[136:151]
    s_add_u32 m0, s99, 65536
    s_nop 0
    buffer_load_dwordx4 v2, s[28:31], s70 offen offset:0 lds
    s_waitcnt lgkmcnt(0)
    v_mfma_f32_32x32x16_bf16 v[88:103], v[200:203], v[208:211], v[88:103]
    ds_read_b64_tr_b16 v[184:185], v14 offset:40960
    ds_read_b64_tr_b16 v[186:187], v14 offset:41984
    ds_read_b128 v[192:195], v12 offset:32768
    v_mfma_f32_32x32x16_bf16 v[120:135], v[204:207], v[208:211], v[120:135]
    ds_read_b64_tr_b16 v[188:189], v15 offset:40960
    ds_read_b64_tr_b16 v[190:191], v15 offset:41984
    ds_read_b128 v[196:199], v12 offset:36864
    v_mfma_f32_32x32x16_bf16 v[152:167], v[200:203], a[252:255], v[152:167]
    buffer_load_dwordx4 v3, s[28:31], s70 offen offset:1024 lds
    s_add_u32 m0, s99, 65536
    s_nop 0
    buffer_load_dwordx4 v4, s[28:31], s70 offen offset:2048 lds
    v_mfma_f32_32x32x16_bf16 v[104:119], v[200:203], v[212:215], v[104:119]
    buffer_load_dwordx4 v5, s[28:31], s70 offen offset:3072 lds
    s_add_u32 m0, s99, 81920
    s_nop 0
    buffer_load_dwordx4 v6, s[44:47], s71 offen offset:0 lds
    v_mfma_f32_32x32x16_bf16 v[136:151], v[204:207], v[212:215], v[136:151]
    buffer_load_dwordx4 v7, s[44:47], s71 offen offset:1024 lds
    s_waitcnt lgkmcnt(0)
    v_mfma_f32_32x32x16_bf16 v[88:103], v[184:187], v[192:195], v[88:103]
    ds_read_b64_tr_b16 v[200:201], v14 offset:45056
    ds_read_b64_tr_b16 v[202:203], v14 offset:46080
    ds_read_b128 v[208:211], v13 offset:32768
    v_mfma_f32_32x32x16_bf16 v[120:135], v[188:191], v[192:195], v[120:135]
    ds_read_b64_tr_b16 v[204:205], v15 offset:45056
    ds_read_b64_tr_b16 v[206:207], v15 offset:46080
    ds_read_b128 v[212:215], v13 offset:36864
    v_mfma_f32_32x32x16_bf16 v[152:167], v[184:187], a[252:255], v[152:167]
    s_add_u32 m0, s99, 81920
    s_nop 0
    buffer_load_dwordx4 v8, s[44:47], s71 offen offset:2048 lds
    buffer_load_dwordx4 v9, s[44:47], s71 offen offset:3072 lds
    v_mfma_f32_32x32x16_bf16 v[104:119], v[184:187], v[196:199], v[104:119]
    v_mov_b32 v37, 0
    v_mfma_f32_32x32x16_bf16 v[136:151], v[188:191], v[196:199], v[136:151]
    ds_write_b32 v67, v37
    s_waitcnt lgkmcnt(0)
    s_waitcnt vmcnt(21)
    s_barrier
    v_mfma_f32_32x32x16_bf16 v[88:103], v[200:203], v[208:211], v[88:103]
    v_xor_b32 v10, 65536, v10
    v_xor_b32 v11, 65536, v11
    v_xor_b32 v12, 65536, v12
    v_xor_b32 v13, 65536, v13
    v_xor_b32 v14, 65536, v14
    v_xor_b32 v15, 65536, v15
    v_mfma_f32_32x32x16_bf16 v[120:135], v[204:207], v[208:211], v[120:135]
    ds_read_b64_tr_b16 v[184:185], v14 offset:0
    ds_read_b64_tr_b16 v[186:187], v14 offset:1024
    ds_read_b128 v[192:195], v10 offset:0
    v_mfma_f32_32x32x16_bf16 v[152:167], v[200:203], a[252:255], v[152:167]
    ds_read_b64_tr_b16 v[188:189], v15 offset:0
    ds_read_b64_tr_b16 v[190:191], v15 offset:1024
    ds_read_b128 v[196:199], v10 offset:4096
    v_mfma_f32_32x32x16_bf16 v[104:119], v[200:203], v[212:215], v[104:119]
    v_mfma_f32_32x32x16_bf16 v[136:151], v[204:207], v[212:215], v[136:151]
    s_waitcnt lgkmcnt(0)
    v_mfma_f32_32x32x16_bf16 v[88:103], v[184:187], v[192:195], v[88:103]
    ds_read_b64_tr_b16 v[200:201], v14 offset:4096
    ds_read_b64_tr_b16 v[202:203], v14 offset:5120
    ds_read_b128 v[208:211], v11 offset:0
    v_mfma_f32_32x32x16_bf16 v[120:135], v[188:191], v[192:195], v[120:135]
    ds_read_b64_tr_b16 v[204:205], v15 offset:4096
    ds_read_b64_tr_b16 v[206:207], v15 offset:5120
    ds_read_b128 v[212:215], v11 offset:4096
    v_mfma_f32_32x32x16_bf16 v[152:167], v[184:187], a[252:255], v[152:167]
    s_lshl_b32 s70, s69, 7
    s_mul_i32 s71, s69, 229376
    v_mfma_f32_32x32x16_bf16 v[104:119], v[184:187], v[196:199], v[104:119]
    s_add_u32 s69, s69, 1
    s_and_b32 s69, s69, 7
    v_mfma_f32_32x32x16_bf16 v[136:151], v[188:191], v[196:199], v[136:151]
    s_add_u32 m0, s99, 98304
    s_nop 0
    buffer_load_dwordx4 v2, s[28:31], s70 offen offset:0 lds
    s_waitcnt lgkmcnt(0)
    v_mfma_f32_32x32x16_bf16 v[88:103], v[200:203], v[208:211], v[88:103]
    ds_read_b64_tr_b16 v[184:185], v14 offset:8192
    ds_read_b64_tr_b16 v[186:187], v14 offset:9216
    ds_read_b128 v[192:195], v12 offset:0
    v_mfma_f32_32x32x16_bf16 v[120:135], v[204:207], v[208:211], v[120:135]
    ds_read_b64_tr_b16 v[188:189], v15 offset:8192
    ds_read_b64_tr_b16 v[190:191], v15 offset:9216
    ds_read_b128 v[196:199], v12 offset:4096
    v_mfma_f32_32x32x16_bf16 v[152:167], v[200:203], a[252:255], v[152:167]
    buffer_load_dwordx4 v3, s[28:31], s70 offen offset:1024 lds
    s_add_u32 m0, s99, 98304
    s_nop 0
    buffer_load_dwordx4 v4, s[28:31], s70 offen offset:2048 lds
    v_mfma_f32_32x32x16_bf16 v[104:119], v[200:203], v[212:215], v[104:119]
    buffer_load_dwordx4 v5, s[28:31], s70 offen offset:3072 lds
    s_add_u32 m0, s99, 114688
    s_nop 0
    buffer_load_dwordx4 v6, s[44:47], s71 offen offset:0 lds
    v_mfma_f32_32x32x16_bf16 v[136:151], v[204:207], v[212:215], v[136:151]
    buffer_load_dwordx4 v7, s[44:47], s71 offen offset:1024 lds
    s_waitcnt lgkmcnt(0)
    v_mfma_f32_32x32x16_bf16 v[88:103], v[184:187], v[192:195], v[88:103]
    ds_read_b64_tr_b16 v[200:201], v14 offset:12288
    ds_read_b64_tr_b16 v[202:203], v14 offset:13312
    ds_read_b128 v[208:211], v13 offset:0
    v_mfma_f32_32x32x16_bf16 v[120:135], v[188:191], v[192:195], v[120:135]
    ds_read_b64_tr_b16 v[204:205], v15 offset:12288
    ds_read_b64_tr_b16 v[206:207], v15 offset:13312
    ds_read_b128 v[212:215], v13 offset:4096
    v_mfma_f32_32x32x16_bf16 v[152:167], v[184:187], a[252:255], v[152:167]
    s_add_u32 m0, s99, 114688
    s_nop 0
    buffer_load_dwordx4 v8, s[44:47], s71 offen offset:2048 lds
    buffer_load_dwordx4 v9, s[44:47], s71 offen offset:3072 lds
    v_mfma_f32_32x32x16_bf16 v[104:119], v[184:187], v[196:199], v[104:119]
    buffer_load_dwordx2 v[56:57], v79, s[56:59], 0 offen sc1
    buffer_load_dword v37, v36, s[56:59], 0 offen sc1
    v_mfma_f32_32x32x16_bf16 v[136:151], v[188:191], v[196:199], v[136:151]
    buffer_load_dwordx2 v[42:43], v80, s[56:59], 0 offen sc1
    s_waitcnt lgkmcnt(0)
    s_waitcnt vmcnt(23)
    s_barrier
    v_mfma_f32_32x32x16_bf16 v[88:103], v[200:203], v[208:211], v[88:103]
    ds_read_b64_tr_b16 v[184:185], v14 offset:32768
    ds_read_b64_tr_b16 v[186:187], v14 offset:33792
    ds_read_b128 v[192:195], v10 offset:32768
    v_mfma_f32_32x32x16_bf16 v[120:135], v[204:207], v[208:211], v[120:135]
    ds_read_b64_tr_b16 v[188:189], v15 offset:32768
    ds_read_b64_tr_b16 v[190:191], v15 offset:33792
    ds_read_b128 v[196:199], v10 offset:36864
    v_mfma_f32_32x32x16_bf16 v[152:167], v[200:203], a[252:255], v[152:167]
    v_mfma_f32_32x32x16_bf16 v[104:119], v[200:203], v[212:215], v[104:119]
    v_mfma_f32_32x32x16_bf16 v[136:151], v[204:207], v[212:215], v[136:151]
    s_waitcnt lgkmcnt(0)
    v_mfma_f32_32x32x16_bf16 v[88:103], v[184:187], v[192:195], v[88:103]
    ds_read_b64_tr_b16 v[200:201], v14 offset:36864
    ds_read_b64_tr_b16 v[202:203], v14 offset:37888
    ds_read_b128 v[208:211], v11 offset:32768
    v_mfma_f32_32x32x16_bf16 v[120:135], v[188:191], v[192:195], v[120:135]
    ds_read_b64_tr_b16 v[204:205], v15 offset:36864
    ds_read_b64_tr_b16 v[206:207], v15 offset:37888
    ds_read_b128 v[212:215], v11 offset:36864
    v_mfma_f32_32x32x16_bf16 v[152:167], v[184:187], a[252:255], v[152:167]
    s_lshl_b32 s3, s73, 4
    s_add_u32 m0, s19, 0
    s_nop 0
    buffer_load_dwordx4 v16, s[48:51], s3 offen offset:0 lds
    v_mfma_f32_32x32x16_bf16 v[104:119], v[184:187], v[196:199], v[104:119]
    buffer_load_dwordx4 v17, s[48:51], s3 offen offset:1024 lds
    v_mfma_f32_32x32x16_bf16 v[136:151], v[188:191], v[196:199], v[136:151]
    s_add_u32 m0, s19, 0
    s_nop 0
    buffer_load_dwordx4 v20, s[48:51], s3 offen offset:2048 lds
    s_waitcnt lgkmcnt(0)
    v_mfma_f32_32x32x16_bf16 v[88:103], v[200:203], v[208:211], v[88:103]
    ds_read_b64_tr_b16 v[184:185], v14 offset:40960
    ds_read_b64_tr_b16 v[186:187], v14 offset:41984
    ds_read_b128 v[192:195], v12 offset:32768
    v_mfma_f32_32x32x16_bf16 v[120:135], v[204:207], v[208:211], v[120:135]
    ds_read_b64_tr_b16 v[188:189], v15 offset:40960
    ds_read_b64_tr_b16 v[190:191], v15 offset:41984
    ds_read_b128 v[196:199], v12 offset:36864
    v_mfma_f32_32x32x16_bf16 v[152:167], v[200:203], a[252:255], v[152:167]
    buffer_load_dwordx4 v24, s[48:51], s3 offen offset:3072 lds
    v_mfma_f32_32x32x16_bf16 v[104:119], v[200:203], v[212:215], v[104:119]
    s_add_u32 s3, s3, 32768
    v_mfma_f32_32x32x16_bf16 v[136:151], v[204:207], v[212:215], v[136:151]
    s_add_u32 m0, s19, 4096
    s_nop 0
    buffer_load_dwordx4 v16, s[48:51], s3 offen offset:0 lds
    s_waitcnt lgkmcnt(0)
    v_mfma_f32_32x32x16_bf16 v[88:103], v[184:187], v[192:195], v[88:103]
    ds_read_b64_tr_b16 v[200:201], v14 offset:45056
    ds_read_b64_tr_b16 v[202:203], v14 offset:46080
    ds_read_b128 v[208:211], v13 offset:32768
    v_mfma_f32_32x32x16_bf16 v[120:135], v[188:191], v[192:195], v[120:135]
    ds_read_b64_tr_b16 v[204:205], v15 offset:45056
    ds_read_b64_tr_b16 v[206:207], v15 offset:46080
    ds_read_b128 v[212:215], v13 offset:36864
    v_mfma_f32_32x32x16_bf16 v[152:167], v[184:187], a[252:255], v[152:167]
    buffer_load_dwordx4 v17, s[48:51], s3 offen offset:1024 lds
    v_mfma_f32_32x32x16_bf16 v[104:119], v[184:187], v[196:199], v[104:119]
    s_add_u32 m0, s19, 4096
    s_nop 0
    buffer_load_dwordx4 v20, s[48:51], s3 offen offset:2048 lds
    v_mfma_f32_32x32x16_bf16 v[136:151], v[188:191], v[196:199], v[136:151]
    buffer_load_dwordx4 v24, s[48:51], s3 offen offset:3072 lds
    s_waitcnt lgkmcnt(0)
    s_waitcnt vmcnt(10)
    v_cmp_ne_u32 vcc, s60, v57
    s_nop 4
    s_cbranch_vccz L_ok_1
    s_mov_b32 s96, 200000
L_spin_2:
    s_sleep 2
    buffer_load_dwordx2 v[56:57], v79, s[56:59], 0 offen sc1
    s_waitcnt vmcnt(0)
    s_sub_u32 s96, s96, 1
    s_cbranch_scc1 L_ok_1
    v_cmp_ne_u32 vcc, s60, v57
    s_nop 4
    s_cbranch_vccnz L_spin_2
L_ok_1:
    s_waitcnt vmcnt(9)
    v_cmp_ne_u32 vcc, s60, v37
    s_nop 4
    s_cbranch_vccz L_ok_3
    s_mov_b32 s96, 200000
L_spin_4:
    s_sleep 2
    buffer_load_dword v37, v36, s[56:59], 0 offen sc1
    s_waitcnt vmcnt(0)
    s_sub_u32 s96, s96, 1
    s_cbranch_scc1 L_ok_3
    v_cmp_ne_u32 vcc, s60, v37
    s_nop 4
    s_cbranch_vccnz L_spin_4
L_ok_3:
    s_barrier
    v_mfma_f32_32x32x16_bf16 v[88:103], v[200:203], v[208:211], v[88:103]
    v_xor_b32 v10, 65536, v10
    v_xor_b32 v11, 65536, v11
    v_xor_b32 v12, 65536, v12
    v_xor_b32 v13, 65536, v13
    v_xor_b32 v14, 65536, v14
    v_xor_b32 v15, 65536, v15
    v_mfma_f32_32x32x16_bf16 v[120:135], v[204:207], v[208:211], v[120:135]
    ds_read_b64_tr_b16 v[184:185], v14 offset:0
    ds_read_b64_tr_b16 v[186:187], v14 offset:1024
    ds_read_b128 v[192:195], v10 offset:0
    v_mfma_f32_32x32x16_bf16 v[152:167], v[200:203], a[252:255], v[152:167]
    ds_read_b64_tr_b16 v[188:189], v15 offset:0
    ds_read_b64_tr_b16 v[190:191], v15 offset:1024
    ds_read_b128 v[196:199], v10 offset:4096
    v_mfma_f32_32x32x16_bf16 v[104:119], v[200:203], v[212:215], v[104:119]
    v_mfma_f32_32x32x16_bf16 v[136:151], v[204:207], v[212:215], v[136:151]
    s_waitcnt lgkmcnt(0)
    v_mfma_f32_32x32x16_bf16 v[88:103], v[184:187], v[192:195], v[88:103]
    ds_read_b64_tr_b16 v[200:201], v14 offset:4096
    ds_read_b64_tr_b16 v[202:203], v14 offset:5120
    ds_read_b128 v[208:211], v11 offset:0
    v_mov_b32 v58, v56
    s_nop 1
    v_permlane32_swap_b32 v56, v58
    v_lshlrev_b32 v57, 16, v56
    v_and_b32 v56, 0xffff0000, v56
    v_rcp_f32 v57, v57
    v_lshlrev_b32 v59, 16, v58
    v_and_b32 v58, 0xffff0000, v58
    v_rcp_f32 v59, v59
    v_mul_f32 v60, 0xbfb8aa3b, v57
    v_mul_f32 v62, 0xbfb8aa3b, v59
    v_mfma_f32_32x32x16_bf16 v[120:135], v[188:191], v[192:195], v[120:135]
    ds_read_b64_tr_b16 v[204:205], v15 offset:4096
    ds_read_b64_tr_b16 v[206:207], v15 offset:5120
    ds_read_b128 v[212:215], v11 offset:4096
    v_mfma_f32_32x32x16_bf16 v[152:167], v[184:187], a[252:255], v[152:167]
    s_lshl_b32 s3, s74, 4
    s_add_u32 m0, s19, 32768
    s_nop 0
    buffer_load_dwordx4 v16, s[48:51], s3 offen offset:0 lds
    v_mfma_f32_32x32x16_bf16 v[104:119], v[184:187], v[196:199], v[104:119]
    buffer_load_dwordx4 v17, s[48:51], s3 offen offset:1024 lds
    v_mfma_f32_32x32x16_bf16 v[136:151], v[188:191], v[196:199], v[136:151]
    s_add_u32 m0, s19, 32768
    s_nop 0
    buffer_load_dwordx4 v20, s[48:51], s3 offen offset:2048 lds
    s_waitcnt lgkmcnt(0)
    v_mfma_f32_32x32x16_bf16 v[88:103], v[200:203], v[208:211], v[88:103]
    ds_read_b64_tr_b16 v[184:185], v14 offset:8192
    ds_read_b64_tr_b16 v[186:187], v14 offset:9216
    ds_read_b128 v[192:195], v12 offset:0
    v_mfma_f32_32x32x16_bf16 v[120:135], v[204:207], v[208:211], v[120:135]
    ds_read_b64_tr_b16 v[188:189], v15 offset:8192
    ds_read_b64_tr_b16 v[190:191], v15 offset:9216
    ds_read_b128 v[196:199], v12 offset:4096
    v_mfma_f32_32x32x16_bf16 v[152:167], v[200:203], a[252:255], v[152:167]
    buffer_load_dwordx4 v24, s[48:51], s3 offen offset:3072 lds
    v_mfma_f32_32x32x16_bf16 v[104:119], v[200:203], v[212:215], v[104:119]
    s_add_u32 s3, s3, 32768
    v_mfma_f32_32x32x16_bf16 v[136:151], v[204:207], v[212:215], v[136:151]
    s_add_u32 m0, s19, 36864
    s_nop 0
    buffer_load_dwordx4 v16, s[48:51], s3 offen offset:0 lds
    s_waitcnt lgkmcnt(0)
    v_mfma_f32_32x32x16_bf16 v[88:103], v[184:187], v[192:195], v[88:103]
    ds_read_b64_tr_b16 v[200:201], v14 offset:12288
    ds_read_b64_tr_b16 v[202:203], v14 offset:13312
    ds_read_b128 v[208:211], v13 offset:0
    v_mfma_f32_32x32x16_bf16 v[120:135], v[188:191], v[192:195], v[120:135]
    ds_read_b64_tr_b16 v[204:205], v15 offset:12288
    ds_read_b64_tr_b16 v[206:207], v15 offset:13312
    ds_read_b128 v[212:215], v13 offset:4096
    v_mfma_f32_32x32x16_bf16 v[152:167], v[184:187], a[252:255], v[152:167]
    buffer_load_dwordx4 v17, s[48:51], s3 offen offset:1024 lds
    v_mfma_f32_32x32x16_bf16 v[104:119], v[184:187], v[196:199], v[104:119]
    s_add_u32 m0, s19, 36864
    s_nop 0
    buffer_load_dwordx4 v20, s[48:51], s3 offen offset:2048 lds
    v_mfma_f32_32x32x16_bf16 v[136:151], v[188:191], v[196:199], v[136:151]
    buffer_load_dwordx4 v24, s[48:51], s3 offen offset:3072 lds
    s_waitcnt lgkmcnt(0)
    s_barrier
    v_mfma_f32_32x32x16_bf16 v[88:103], v[200:203], v[208:211], v[88:103]
    ds_read_b64_tr_b16 v[184:185], v14 offset:32768
    ds_read_b64_tr_b16 v[186:187], v14 offset:33792
    ds_read_b128 v[192:195], v10 offset:32768
    v_mfma_f32_32x32x16_bf16 v[120:135], v[204:207], v[208:211], v[120:135]
    ds_read_b64_tr_b16 v[188:189], v15 offset:32768
    ds_read_b64_tr_b16 v[190:191], v15 offset:33792
    ds_read_b128 v[196:199], v10 offset:36864
    v_mfma_f32_32x32x16_bf16 v[152:167], v[200:203], a[252:255], v[152:167]
    v_mfma_f32_32x32x16_bf16 v[104:119], v[200:203], v[212:215], v[104:119]
    v_mfma_f32_32x32x16_bf16 v[136:151], v[204:207], v[212:215], v[136:151]
    s_waitcnt lgkmcnt(0)
    v_mfma_f32_32x32x16_bf16 v[88:103], v[184:187], v[192:195], v[88:103]
    ds_read_b64_tr_b16 v[200:201], v14 offset:36864
    ds_read_b64_tr_b16 v[202:203], v14 offset:37888
    ds_read_b128 v[208:211], v11 offset:32768
    v_mfma_f32_32x32x16_bf16 v[120:135], v[188:191], v[192:195], v[120:135]
    ds_read_b64_tr_b16 v[204:205], v15 offset:36864
    ds_read_b64_tr_b16 v[206:207], v15 offset:37888
    ds_read_b128 v[212:215], v11 offset:36864
    v_mfma_f32_32x32x16_bf16 v[152:167], v[184:187], a[252:255], v[152:167]
    s_lshl_b32 s3, s75, 4
    s_add_u32 m0, s19, 65536
    s_nop 0
    buffer_load_dwordx4 v16, s[48:51], s3 offen offset:0 lds
    v_mfma_f32_32x32x16_bf16 v[104:119], v[184:187], v[196:199], v[104:119]
    buffer_load_dwordx4 v17, s[48:51], s3 offen offset:1024 lds
    v_mfma_f32_32x32x16_bf16 v[136:151], v[188:191], v[196:199], v[136:151]
    s_add_u32 m0, s19, 65536
    s_nop 0
    buffer_load_dwordx4 v20, s[48:51], s3 offen offset:2048 lds
    s_waitcnt lgkmcnt(0)
    v_mfma_f32_32x32x16_bf16 v[88:103], v[200:203], v[208:211], v[88:103]
    ds_read_b64_tr_b16 v[184:185], v14 offset:40960
    ds_read_b64_tr_b16 v[186:187], v14 offset:41984
    ds_read_b128 v[192:195], v12 offset:32768
    v_mfma_f32_32x32x16_bf16 v[120:135], v[204:207], v[208:211], v[120:135]
    ds_read_b64_tr_b16 v[188:189], v15 offset:40960
    ds_read_b64_tr_b16 v[190:191], v15 offset:41984
    ds_read_b128 v[196:199], v12 offset:36864
    v_mfma_f32_32x32x16_bf16 v[152:167], v[200:203], a[252:255], v[152:167]
    buffer_load_dwordx4 v24, s[48:51], s3 offen offset:3072 lds
    v_mfma_f32_32x32x16_bf16 v[104:119], v[200:203], v[212:215], v[104:119]
    s_add_u32 s3, s3, 32768
    v_mfma_f32_32x32x16_bf16 v[136:151], v[204:207], v[212:215], v[136:151]
    s_add_u32 m0, s19, 69632
    s_nop 0
    buffer_load_dwordx4 v16, s[48:51], s3 offen offset:0 lds
    s_waitcnt lgkmcnt(0)
    v_mfma_f32_32x32x16_bf16 v[88:103], v[184:187], v[192:195], v[88:103]
    ds_read_b64_tr_b16 v[200:201], v14 offset:45056
    ds_read_b64_tr_b16 v[202:203], v14 offset:46080
    ds_read_b128 v[208:211], v13 offset:32768
    v_mfma_f32_32x32x16_bf16 v[120:135], v[188:191], v[192:195], v[120:135]
    ds_read_b64_tr_b16 v[204:205], v15 offset:45056
    ds_read_b64_tr_b16 v[206:207], v15 offset:46080
    ds_read_b128 v[212:215], v13 offset:36864
    v_mfma_f32_32x32x16_bf16 v[152:167], v[184:187], a[252:255], v[152:167]
    buffer_load_dwordx4 v17, s[48:51], s3 offen offset:1024 lds
    v_mfma_f32_32x32x16_bf16 v[104:119], v[184:187], v[196:199], v[104:119]
    s_add_u32 m0, s19, 69632
    s_nop 0
    buffer_load_dwordx4 v20, s[48:51], s3 offen offset:2048 lds
    v_mfma_f32_32x32x16_bf16 v[136:151], v[188:191], v[196:199], v[136:151]
    buffer_load_dwordx4 v24, s[48:51], s3 offen offset:3072 lds
    s_waitcnt lgkmcnt(0)
    v_mfma_f32_32x32x16_bf16 v[152:167], v[200:203], a[252:255], v[152:167]
    s_mov_b32 exec_lo, 1
    s_mov_b32 exec_hi, 1
    s_nop 9
    ds_write_b128 v76, v[152:155] offset:0
    ds_write_b128 v76, v[156:159] offset:16
    ds_write_b128 v76, v[160:163] offset:32
    ds_write_b128 v76, v[164:167] offset:48
    s_mov_b64 exec, -1
    s_waitcnt lgkmcnt(0)
    s_barrier
    v_mfma_f32_32x32x16_bf16 v[88:103], v[200:203], v[208:211], v[88:103]
    ds_read_b128 v[168:171], v77 offset:0
    ds_read_b128 v[172:175], v77 offset:16
    ds_read_b128 v[176:179], v77 offset:32
    ds_read_b128 v[180:183], v77 offset:48
    v_mfma_f32_32x32x16_bf16 v[120:135], v[204:207], v[208:211], v[120:135]
    v_mfma_f32_32x32x16_bf16 v[104:119], v[200:203], v[212:215], v[104:119]
    v_mfma_f32_32x32x16_bf16 v[136:151], v[204:207], v[212:215], v[136:151]
    s_mov_b32 m0, s4
    s_nop 0
    buffer_load_dwordx4 v78, s[56:59], 0 offen sc1 lds
    buffer_load_dwordx4 v78, s[56:59], 0 offen offset:1024 sc1 lds
    s_nop 0
    v_pk_fma_f32 v[184:185], v[152:153], v[56:57], v[88:89] op_sel_hi:[1,0,1] neg_lo:[0,1,0] neg_hi:[0,1,0]
    v_pk_fma_f32 v[186:187], v[154:155], v[56:57], v[90:91] op_sel_hi:[1,0,1] neg_lo:[0,1,0] neg_hi:[0,1,0]
    v_pk_mul_f32 v[184:185], v[184:185], v[60:61] op_sel_hi:[1,0]
    v_pk_mul_f32 v[186:187], v[186:187], v[60:61] op_sel_hi:[1,0]
    v_exp_f32 v188, v184
    v_exp_f32 v189, v185
    v_exp_f32 v190, v186
    v_exp_f32 v191, v187
    v_pk_fma_f32 v[188:189], v[188:189], v[60:61], v[60:61] op_sel:[0,1,1] op_sel_hi:[1,1,1]
    v_pk_fma_f32 v[190:191], v[190:191], v[60:61], v[60:61] op_sel:[0,1,1] op_sel_hi:[1,1,1]
    v_rcp_f32 v188, v188
    v_rcp_f32 v189, v189
    v_rcp_f32 v190, v190
    v_rcp_f32 v191, v191
    v_pk_mul_f32 v[184:185], v[184:185], v[188:189]
    v_pk_mul_f32 v[186:187], v[186:187], v[190:191]
    v_cvt_pk_bf16_f32 v200, v184, v185
    v_cvt_pk_bf16_f32 v201, v186, v187
    v_add_u32 v14, 65536, v21
    v_add_u32 v15, 65536, v0
    s_waitcnt vmcnt(18)
    ds_read_b64_tr_b16 a[0:1], v21 offset:0
    ds_read_b64_tr_b16 a[2:3], v21 offset:1024
    ds_read_b64_tr_b16 a[4:5], v0 offset:0
    ds_read_b64_tr_b16 a[6:7], v0 offset:1024
    ds_read_b64_tr_b16 a[8:9], v21 offset:2048
    ds_read_b64_tr_b16 a[10:11], v21 offset:3072
    ds_read_b64_tr_b16 a[12:13], v0 offset:2048
    ds_read_b64_tr_b16 a[14:15], v0 offset:3072
    ds_read_b64_tr_b16 a[16:17], v21 offset:4096
    ds_read_b64_tr_b16 a[18:19], v21 offset:5120
    ds_read_b64_tr_b16 a[20:21], v0 offset:4096
    ds_read_b64_tr_b16 a[22:23], v0 offset:5120
    ds_read_b64_tr_b16 a[24:25], v21 offset:6144
    ds_read_b64_tr_b16 a[26:27], v21 offset:7168
    ds_read_b64_tr_b16 a[28:29], v0 offset:6144
    ds_read_b64_tr_b16 a[30:31], v0 offset:7168
    s_waitcnt lgkmcnt(0)
    s_lshl_b32 s3, s76, 4
    s_add_u32 m0, s19, 0
    s_nop 0
    buffer_load_dwordx4 v16, s[48:51], s3 offen offset:0 lds
    buffer_load_dwordx4 v17, s[48:51], s3 offen offset:1024 lds
    s_add_u32 m0, s19, 0
    s_nop 0
    buffer_load_dwordx4 v20, s[48:51], s3 offen offset:2048 lds
    buffer_load_dwordx4 v24, s[48:51], s3 offen offset:3072 lds
    s_add_u32 s3, s3, 32768
    s_add_u32 m0, s19, 4096
    s_nop 0
    buffer_load_dwordx4 v16, s[48:51], s3 offen offset:0 lds
    buffer_load_dwordx4 v17, s[48:51], s3 offen offset:1024 lds
    s_add_u32 m0, s19, 4096
    s_nop 0
    buffer_load_dwordx4 v20, s[48:51], s3 offen offset:2048 lds
    buffer_load_dwordx4 v24, s[48:51], s3 offen offset:3072 lds
    v_pk_fma_f32 v[192:193], v[156:157], v[56:57], v[92:93] op_sel_hi:[1,0,1] neg_lo:[0,1,0] neg_hi:[0,1,0]
    v_pk_fma_f32 v[194:195], v[158:159], v[56:57], v[94:95] op_sel_hi:[1,0,1] neg_lo:[0,1,0] neg_hi:[0,1,0]
    v_pk_mul_f32 v[192:193], v[192:193], v[60:61] op_sel_hi:[1,0]
    v_pk_mul_f32 v[194:195], v[194:195], v[60:61] op_sel_hi:[1,0]
    v_exp_f32 v196, v192
    v_exp_f32 v197, v193
    v_exp_f32 v198, v194
    v_exp_f32 v199, v195
    v_pk_fma_f32 v[196:197], v[196:197], v[60:61], v[60:61] op_sel:[0,1,1] op_sel_hi:[1,1,1]
    v_pk_fma_f32 v[198:199], v[198:199], v[60:61], v[60:61] op_sel:[0,1,1] op_sel_hi:[1,1,1]
    v_rcp_f32 v196, v196
    v_rcp_f32 v197, v197
    v_rcp_f32 v198, v198
    v_rcp_f32 v199, v199
    v_pk_mul_f32 v[192:193], v[192:193], v[196:197]
    v_pk_mul_f32 v[194:195], v[194:195], v[198:199]
    v_cvt_pk_bf16_f32 v202, v192, v193
    v_cvt_pk_bf16_f32 v203, v194, v195
    buffer_store_dwordx4 v[200:203], v38, s[56:59], 0 offen offset:0 sc1
    v_mov_b64 v[216:217], 0
    v_mov_b64 v[218:219], 0
    s_mov_b64 exec, 255
    ds_write_b128 v66, v[216:219]
    s_mov_b64 exec, -1
    v_pk_fma_f32 v[184:185], v[160:161], v[56:57], v[96:97] op_sel_hi:[1,0,1] neg_lo:[0,1,0] neg_hi:[0,1,0]
    v_pk_fma_f32 v[186:187], v[162:163], v[56:57], v[98:99] op_sel_hi:[1,0,1] neg_lo:[0,1,0] neg_hi:[0,1,0]
    v_pk_mul_f32 v[184:185], v[184:185], v[60:61] op_sel_hi:[1,0]
    v_pk_mul_f32 v[186:187], v[186:187], v[60:61] op_sel_hi:[1,0]
    v_exp_f32 v188, v184
    v_exp_f32 v189, v185
    v_exp_f32 v190, v186
    v_exp_f32 v191, v187
    v_pk_fma_f32 v[188:189], v[188:189], v[60:61], v[60:61] op_sel:[0,1,1] op_sel_hi:[1,1,1]
    v_pk_fma_f32 v[190:191], v[190:191], v[60:61], v[60:61] op_sel:[0,1,1] op_sel_hi:[1,1,1]
    v_rcp_f32 v188, v188
    v_rcp_f32 v189, v189
    v_rcp_f32 v190, v190
    v_rcp_f32 v191, v191
    v_pk_mul_f32 v[184:185], v[184:185], v[188:189]
    v_pk_mul_f32 v[186:187], v[186:187], v[190:191]
    v_cvt_pk_bf16_f32 v204, v184, v185
    v_cvt_pk_bf16_f32 v205, v186, v187
    ds_write_b128 v83, v[46:49] offset:0
    v_pk_fma_f32 v[192:193], v[164:165], v[56:57], v[100:101] op_sel_hi:[1,0,1] neg_lo:[0,1,0] neg_hi:[0,1,0]
    v_pk_fma_f32 v[194:195], v[166:167], v[56:57], v[102:103] op_sel_hi:[1,0,1] neg_lo:[0,1,0] neg_hi:[0,1,0]
    v_pk_mul_f32 v[192:193], v[192:193], v[60:61] op_sel_hi:[1,0]
    v_pk_mul_f32 v[194:195], v[194:195], v[60:61] op_sel_hi:[1,0]
    v_exp_f32 v196, v192
    v_exp_f32 v197, v193
    v_exp_f32 v198, v194
    v_exp_f32 v199, v195
    v_pk_fma_f32 v[196:197], v[196:197], v[60:61], v[60:61] op_sel:[0,1,1] op_sel_hi:[1,1,1]
    v_pk_fma_f32 v[198:199], v[198:199], v[60:61], v[60:61] op_sel:[0,1,1] op_sel_hi:[1,1,1]
    v_rcp_f32 v196, v196
    v_rcp_f32 v197, v197
    v_rcp_f32 v198, v198
    v_rcp_f32 v199, v199
    v_pk_mul_f32 v[192:193], v[192:193], v[196:197]
    v_pk_mul_f32 v[194:195], v[194:195], v[198:199]
    v_cvt_pk_bf16_f32 v206, v192, v193
    v_cvt_pk_bf16_f32 v207, v194, v195
    buffer_store_dwordx4 v[204:207], v38, s[56:59], 0 offen offset:1024 sc1
    v_pk_fma_f32 v[184:185], v[168:169], v[56:57], v[120:121] op_sel_hi:[1,0,1] neg_lo:[0,1,0] neg_hi:[0,1,0]
    v_pk_fma_f32 v[186:187], v[170:171], v[56:57], v[122:123] op_sel_hi:[1,0,1] neg_lo:[0,1,0] neg_hi:[0,1,0]
    v_pk_mul_f32 v[184:185], v[184:185], v[60:61] op_sel_hi:[1,0]
    v_pk_mul_f32 v[186:187], v[186:187], v[60:61] op_sel_hi:[1,0]
    v_exp_f32 v188, v184
    v_exp_f32 v189, v185
    v_exp_f32 v190, v186
    v_exp_f32 v191, v187
    v_pk_fma_f32 v[188:189], v[188:189], v[60:61], v[60:61] op_sel:[0,1,1] op_sel_hi:[1,1,1]
    v_pk_fma_f32 v[190:191], v[190:191], v[60:61], v[60:61] op_sel:[0,1,1] op_sel_hi:[1,1,1]
    v_rcp_f32 v188, v188
    v_rcp_f32 v189, v189
    v_rcp_f32 v190, v190
    v_rcp_f32 v191, v191
    v_pk_mul_f32 v[184:185], v[184:185], v[188:189]
    v_pk_mul_f32 v[186:187], v[186:187], v[190:191]
    v_cvt_pk_bf16_f32 v208, v184, v185
    v_cvt_pk_bf16_f32 v209, v186, v187
    v_alignbit_b32 v220, v46, v45, 16
    v_alignbit_b32 v221, v47, v46, 16
    v_alignbit_b32 v222, v48, v47, 16
    v_alignbit_b32 v223, v49, v48, 16
    ds_write_b128 v83, v[220:223] offset:4160
    v_pk_fma_f32 v[192:193], v[172:173], v[56:57], v[124:125] op_sel_hi:[1,0,1] neg_lo:[0,1,0] neg_hi:[0,1,0]
    v_pk_fma_f32 v[194:195], v[174:175], v[56:57], v[126:127] op_sel_hi:[1,0,1] neg_lo:[0,1,0] neg_hi:[0,1,0]
    v_pk_mul_f32 v[192:193], v[192:193], v[60:61] op_sel_hi:[1,0]
    v_pk_mul_f32 v[194:195], v[194:195], v[60:61] op_sel_hi:[1,0]
    v_exp_f32 v196, v192
    v_exp_f32 v197, v193
    v_exp_f32 v198, v194
    v_exp_f32 v199, v195
    v_pk_fma_f32 v[196:197], v[196:197], v[60:61], v[60:61] op_sel:[0,1,1] op_sel_hi:[1,1,1]
    v_pk_fma_f32 v[198:199], v[198:199], v[60:61], v[60:61] op_sel:[0,1,1] op_sel_hi:[1,1,1]
    v_rcp_f32 v196, v196
    v_rcp_f32 v197, v197
    v_rcp_f32 v198, v198
    v_rcp_f32 v199, v199
    v_pk_mul_f32 v[192:193], v[192:193], v[196:197]
    v_pk_mul_f32 v[194:195], v[194:195], v[198:199]
    v_cvt_pk_bf16_f32 v210, v192, v193
    v_cvt_pk_bf16_f32 v211, v194, v195
    buffer_store_dwordx4 v[208:211], v39, s[56:59], 0 offen offset:0 sc1
    v_mov_b32 v224, v45
    v_mov_b32 v225, v46
    v_mov_b32 v226, v47
    v_mov_b32 v227, v48
    ds_write_b128 v83, v[224:227] offset:8320
    v_pk_fma_f32 v[184:185], v[176:177], v[56:57], v[128:129] op_sel_hi:[1,0,1] neg_lo:[0,1,0] neg_hi:[0,1,0]
    v_pk_fma_f32 v[186:187], v[178:179], v[56:57], v[130:131] op_sel_hi:[1,0,1] neg_lo:[0,1,0] neg_hi:[0,1,0]
    v_pk_mul_f32 v[184:185], v[184:185], v[60:61] op_sel_hi:[1,0]
    v_pk_mul_f32 v[186:187], v[186:187], v[60:61] op_sel_hi:[1,0]
    v_exp_f32 v188, v184
    v_exp_f32 v189, v185
    v_exp_f32 v190, v186
    v_exp_f32 v191, v187
    v_pk_fma_f32 v[188:189], v[188:189], v[60:61], v[60:61] op_sel:[0,1,1] op_sel_hi:[1,1,1]
    v_pk_fma_f32 v[190:191], v[190:191], v[60:61], v[60:61] op_sel:[0,1,1] op_sel_hi:[1,1,1]
    v_rcp_f32 v188, v188
    v_rcp_f32 v189, v189
    v_rcp_f32 v190, v190
    v_rcp_f32 v191, v191
    v_pk_mul_f32 v[184:185], v[184:185], v[188:189]
    v_pk_mul_f32 v[186:187], v[186:187], v[190:191]
    v_cvt_pk_bf16_f32 v212, v184, v185
    v_cvt_pk_bf16_f32 v213, v186, v187
    v_pk_fma_f32 v[192:193], v[180:181], v[56:57], v[132:133] op_sel_hi:[1,0,1] neg_lo:[0,1,0] neg_hi:[0,1,0]
    v_pk_fma_f32 v[194:195], v[182:183], v[56:57], v[134:135] op_sel_hi:[1,0,1] neg_lo:[0,1,0] neg_hi:[0,1,0]
    v_pk_mul_f32 v[192:193], v[192:193], v[60:61] op_sel_hi:[1,0]
    v_pk_mul_f32 v[194:195], v[194:195], v[60:61] op_sel_hi:[1,0]
    v_exp_f32 v196, v192
    v_exp_f32 v197, v193
    v_exp_f32 v198, v194
    v_exp_f32 v199, v195
    v_pk_fma_f32 v[196:197], v[196:197], v[60:61], v[60:61] op_sel:[0,1,1] op_sel_hi:[1,1,1]
    v_pk_fma_f32 v[198:199], v[198:199], v[60:61], v[60:61] op_sel:[0,1,1] op_sel_hi:[1,1,1]
    v_rcp_f32 v196, v196
    v_rcp_f32 v197, v197
    v_rcp_f32 v198, v198
    v_rcp_f32 v199, v199
    v_pk_mul_f32 v[192:193], v[192:193], v[196:197]
    v_pk_mul_f32 v[194:195], v[194:195], v[198:199]
    v_cvt_pk_bf16_f32 v214, v192, v193
    v_cvt_pk_bf16_f32 v215, v194, v195
    buffer_store_dwordx4 v[212:215], v39, s[56:59], 0 offen offset:1024 sc1
    v_alignbit_b32 v228, v45, v44, 16
    v_alignbit_b32 v229, v46, v45, 16
    v_alignbit_b32 v230, v47, v46, 16
    v_alignbit_b32 v231, v48, v47, 16
    ds_write_b128 v83, v[228:231] offset:12480
    v_pk_fma_f32 v[184:185], v[152:153], v[58:59], v[104:105] op_sel_hi:[1,0,1] neg_lo:[0,1,0] neg_hi:[0,1,0]
    v_pk_fma_f32 v[186:187], v[154:155], v[58:59], v[106:107] op_sel_hi:[1,0,1] neg_lo:[0,1,0] neg_hi:[0,1,0]
    v_pk_mul_f32 v[184:185], v[184:185], v[62:63] op_sel_hi:[1,0]
    v_pk_mul_f32 v[186:187], v[186:187], v[62:63] op_sel_hi:[1,0]
    v_exp_f32 v188, v184
    v_exp_f32 v189, v185
    v_exp_f32 v190, v186
    v_exp_f32 v191, v187
    v_pk_fma_f32 v[188:189], v[188:189], v[60:61], v[60:61] op_sel:[0,1,1] op_sel_hi:[1,1,1]
    v_pk_fma_f32 v[190:191], v[190:191], v[60:61], v[60:61] op_sel:[0,1,1] op_sel_hi:[1,1,1]
    v_rcp_f32 v188, v188
    v_rcp_f32 v189, v189
    v_rcp_f32 v190, v190
    v_rcp_f32 v191, v191
    v_pk_mul_f32 v[184:185], v[184:185], v[188:189]
    v_pk_mul_f32 v[186:187], v[186:187], v[190:191]
    v_cvt_pk_bf16_f32 v200, v184, v185
    v_cvt_pk_bf16_f32 v201, v186, v187
    ds_write_b128 v83, v[52:55] offset:1024
    v_pk_fma_f32 v[192:193], v[156:157], v[58:59], v[108:109] op_sel_hi:[1,0,1] neg_lo:[0,1,0] neg_hi:[0,1,0]
    v_pk_fma_f32 v[194:195], v[158:159], v[58:59], v[110:111] op_sel_hi:[1,0,1] neg_lo:[0,1,0] neg_hi:[0,1,0]
    v_pk_mul_f32 v[192:193], v[192:193], v[62:63] op_sel_hi:[1,0]
    v_pk_mul_f32 v[194:195], v[194:195], v[62:63] op_sel_hi:[1,0]
    v_exp_f32 v196, v192
    v_exp_f32 v197, v193
    v_exp_f32 v198, v194
    v_exp_f32 v199, v195
    v_pk_fma_f32 v[196:197], v[196:197], v[60:61], v[60:61] op_sel:[0,1,1] op_sel_hi:[1,1,1]
    v_pk_fma_f32 v[198:199], v[198:199], v[60:61], v[60:61] op_sel:[0,1,1] op_sel_hi:[1,1,1]
    v_rcp_f32 v196, v196
    v_rcp_f32 v197, v197
    v_rcp_f32 v198, v198
    v_rcp_f32 v199, v199
    v_pk_mul_f32 v[192:193], v[192:193], v[196:197]
    v_pk_mul_f32 v[194:195], v[194:195], v[198:199]
    v_cvt_pk_bf16_f32 v202, v192, v193
    v_cvt_pk_bf16_f32 v203, v194, v195
    buffer_store_dwordx4 v[200:203], v38, s[56:59], s13 offen offset:0 sc1
    v_pk_fma_f32 v[184:185], v[160:161], v[58:59], v[112:113] op_sel_hi:[1,0,1] neg_lo:[0,1,0] neg_hi:[0,1,0]
    v_pk_fma_f32 v[186:187], v[162:163], v[58:59], v[114:115] op_sel_hi:[1,0,1] neg_lo:[0,1,0] neg_hi:[0,1,0]
    v_pk_mul_f32 v[184:185], v[184:185], v[62:63] op_sel_hi:[1,0]
    v_pk_mul_f32 v[186:187], v[186:187], v[62:63] op_sel_hi:[1,0]
    v_exp_f32 v188, v184
    v_exp_f32 v189, v185
    v_exp_f32 v190, v186
    v_exp_f32 v191, v187
    v_pk_fma_f32 v[188:189], v[188:189], v[60:61], v[60:61] op_sel:[0,1,1] op_sel_hi:[1,1,1]
    v_pk_fma_f32 v[190:191], v[190:191], v[60:61], v[60:61] op_sel:[0,1,1] op_sel_hi:[1,1,1]
    v_rcp_f32 v188, v188
    v_rcp_f32 v189, v189
    v_rcp_f32 v190, v190
    v_rcp_f32 v191, v191
    v_pk_mul_f32 v[184:185], v[184:185], v[188:189]
    v_pk_mul_f32 v[186:187], v[186:187], v[190:191]
    v_cvt_pk_bf16_f32 v204, v184, v185
    v_cvt_pk_bf16_f32 v205, v186, v187
    v_alignbit_b32 v220, v52, v51, 16
    v_alignbit_b32 v221, v53, v52, 16
    v_alignbit_b32 v222, v54, v53, 16
    v_alignbit_b32 v223, v55, v54, 16
    ds_write_b128 v83, v[220:223] offset:5184
    v_pk_fma_f32 v[192:193], v[164:165], v[58:59], v[116:117] op_sel_hi:[1,0,1] neg_lo:[0,1,0] neg_hi:[0,1,0]
    v_pk_fma_f32 v[194:195], v[166:167], v[58:59], v[118:119] op_sel_hi:[1,0,1] neg_lo:[0,1,0] neg_hi:[0,1,0]
    v_pk_mul_f32 v[192:193], v[192:193], v[62:63] op_sel_hi:[1,0]
    v_pk_mul_f32 v[194:195], v[194:195], v[62:63] op_sel_hi:[1,0]
    v_exp_f32 v196, v192
    v_exp_f32 v197, v193
    v_exp_f32 v198, v194
    v_exp_f32 v199, v195
    v_pk_fma_f32 v[196:197], v[196:197], v[60:61], v[60:61] op_sel:[0,1,1] op_sel_hi:[1,1,1]
    v_pk_fma_f32 v[198:199], v[198:199], v[60:61], v[60:61] op_sel:[0,1,1] op_sel_hi:[1,1,1]
    v_rcp_f32 v196, v196
    v_rcp_f32 v197, v197
    v_rcp_f32 v198, v198
    v_rcp_f32 v199, v199
    v_pk_mul_f32 v[192:193], v[192:193], v[196:197]
    v_pk_mul_f32 v[194:195], v[194:195], v[198:199]
    v_cvt_pk_bf16_f32 v206, v192, v193
    v_cvt_pk_bf16_f32 v207, v194, v195
    buffer_store_dwordx4 v[204:207], v38, s[56:59], s13 offen offset:1024 sc1
    v_mov_b32 v224, v51
    v_mov_b32 v225, v52
    v_mov_b32 v226, v53
    v_mov_b32 v227, v54
    ds_write_b128 v83, v[224:227] offset:9344
    v_pk_fma_f32 v[184:185], v[168:169], v[58:59], v[136:137] op_sel_hi:[1,0,1] neg_lo:[0,1,0] neg_hi:[0,1,0]
    v_pk_fma_f32 v[186:187], v[170:171], v[58:59], v[138:139] op_sel_hi:[1,0,1] neg_lo:[0,1,0] neg_hi:[0,1,0]
    v_pk_mul_f32 v[184:185], v[184:185], v[62:63] op_sel_hi:[1,0]
    v_pk_mul_f32 v[186:187], v[186:187], v[62:63] op_sel_hi:[1,0]
    v_exp_f32 v188, v184
    v_exp_f32 v189, v185
    v_exp_f32 v190, v186
    v_exp_f32 v191, v187
    v_pk_fma_f32 v[188:189], v[188:189], v[60:61], v[60:61] op_sel:[0,1,1] op_sel_hi:[1,1,1]
    v_pk_fma_f32 v[190:191], v[190:191], v[60:61], v[60:61] op_sel:[0,1,1] op_sel_hi:[1,1,1]
    v_rcp_f32 v188, v188
    v_rcp_f32 v189, v189
    v_rcp_f32 v190, v190
    v_rcp_f32 v191, v191
    v_pk_mul_f32 v[184:185], v[184:185], v[188:189]
    v_pk_mul_f32 v[186:187], v[186:187], v[190:191]
    v_cvt_pk_bf16_f32 v208, v184, v185
    v_cvt_pk_bf16_f32 v209, v186, v187
    v_pk_fma_f32 v[192:193], v[172:173], v[58:59], v[140:141] op_sel_hi:[1,0,1] neg_lo:[0,1,0] neg_hi:[0,1,0]
    v_pk_fma_f32 v[194:195], v[174:175], v[58:59], v[142:143] op_sel_hi:[1,0,1] neg_lo:[0,1,0] neg_hi:[0,1,0]
    v_pk_mul_f32 v[192:193], v[192:193], v[62:63] op_sel_hi:[1,0]
    v_pk_mul_f32 v[194:195], v[194:195], v[62:63] op_sel_hi:[1,0]
    v_exp_f32 v196, v192
    v_exp_f32 v197, v193
    v_exp_f32 v198, v194
    v_exp_f32 v199, v195
    v_pk_fma_f32 v[196:197], v[196:197], v[60:61], v[60:61] op_sel:[0,1,1] op_sel_hi:[1,1,1]
    v_pk_fma_f32 v[198:199], v[198:199], v[60:61], v[60:61] op_sel:[0,1,1] op_sel_hi:[1,1,1]
    v_rcp_f32 v196, v196
    v_rcp_f32 v197, v197
    v_rcp_f32 v198, v198
    v_rcp_f32 v199, v199
    v_pk_mul_f32 v[192:193], v[192:193], v[196:197]
    v_pk_mul_f32 v[194:195], v[194:195], v[198:199]
    v_cvt_pk_bf16_f32 v210, v192, v193
    v_cvt_pk_bf16_f32 v211, v194, v195
    buffer_store_dwordx4 v[208:211], v39, s[56:59], s13 offen offset:0 sc1
    v_alignbit_b32 v228, v51, v50, 16
    v_alignbit_b32 v229, v52, v51, 16
    v_alignbit_b32 v230, v53, v52, 16
    v_alignbit_b32 v231, v54, v53, 16
    ds_write_b128 v83, v[228:231] offset:13504
    v_pk_fma_f32 v[184:185], v[176:177], v[58:59], v[144:145] op_sel_hi:[1,0,1] neg_lo:[0,1,0] neg_hi:[0,1,0]
    v_pk_fma_f32 v[186:187], v[178:179], v[58:59], v[146:147] op_sel_hi:[1,0,1] neg_lo:[0,1,0] neg_hi:[0,1,0]
    v_pk_mul_f32 v[184:185], v[184:185], v[62:63] op_sel_hi:[1,0]
    v_pk_mul_f32 v[186:187], v[186:187], v[62:63] op_sel_hi:[1,0]
    v_exp_f32 v188, v184
    v_exp_f32 v189, v185
    v_exp_f32 v190, v186
    v_exp_f32 v191, v187
    v_pk_fma_f32 v[188:189], v[188:189], v[60:61], v[60:61] op_sel:[0,1,1] op_sel_hi:[1,1,1]
    v_pk_fma_f32 v[190:191], v[190:191], v[60:61], v[60:61] op_sel:[0,1,1] op_sel_hi:[1,1,1]
    v_rcp_f32 v188, v188
    v_rcp_f32 v189, v189
    v_rcp_f32 v190, v190
    v_rcp_f32 v191, v191
    v_pk_mul_f32 v[184:185], v[184:185], v[188:189]
    v_pk_mul_f32 v[186:187], v[186:187], v[190:191]
    v_cvt_pk_bf16_f32 v212, v184, v185
    v_cvt_pk_bf16_f32 v213, v186, v187
    v_pk_fma_f32 v[192:193], v[180:181], v[58:59], v[148:149] op_sel_hi:[1,0,1] neg_lo:[0,1,0] neg_hi:[0,1,0]
    v_pk_fma_f32 v[194:195], v[182:183], v[58:59], v[150:151] op_sel_hi:[1,0,1] neg_lo:[0,1,0] neg_hi:[0,1,0]
    v_pk_mul_f32 v[192:193], v[192:193], v[62:63] op_sel_hi:[1,0]
    v_pk_mul_f32 v[194:195], v[194:195], v[62:63] op_sel_hi:[1,0]
    v_exp_f32 v196, v192
    v_exp_f32 v197, v193
    v_exp_f32 v198, v194
    v_exp_f32 v199, v195
    v_pk_fma_f32 v[196:197], v[196:197], v[60:61], v[60:61] op_sel:[0,1,1] op_sel_hi:[1,1,1]
    v_pk_fma_f32 v[198:199], v[198:199], v[60:61], v[60:61] op_sel:[0,1,1] op_sel_hi:[1,1,1]
    v_rcp_f32 v196, v196
    v_rcp_f32 v197, v197
    v_rcp_f32 v198, v198
    v_rcp_f32 v199, v199
    v_pk_mul_f32 v[192:193], v[192:193], v[196:197]
    v_pk_mul_f32 v[194:195], v[194:195], v[198:199]
    v_cvt_pk_bf16_f32 v214, v192, v193
    v_cvt_pk_bf16_f32 v215, v194, v195
    buffer_store_dwordx4 v[212:215], v39, s[56:59], s13 offen offset:1024 sc1
    s_waitcnt vmcnt(16) lgkmcnt(0)
    s_barrier
L_conv:
    ds_read_b128 v[120:123], v65 offset:192
    ds_read_b64 v[184:185], v64 offset:0
    ds_read_b64 v[186:187], v64 offset:8
    ds_read_b128 v[124:127], v65 offset:704
    ds_read_b64 v[188:189], v64 offset:512
    ds_read_b64 v[190:191], v64 offset:520
    ds_read_b128 v[128:131], v65 offset:1216
    ds_read_b64 v[192:193], v64 offset:1024
    ds_read_b64 v[194:195], v64 offset:1032
    ds_read_b128 v[132:135], v65 offset:1728
    ds_read_b64 v[196:197], v64 offset:1536
    ds_read_b64 v[198:199], v64 offset:1544
    ds_read_b128 v[136:139], v65 offset:2240
    ds_read_b128 v[140:143], v65 offset:2752
    ds_read_b128 v[144:147], v65 offset:3264
    ds_read_b128 v[148:151], v65 offset:3776
    s_waitcnt lgkmcnt(13)
    v_mfma_f32_16x16x32_bf16 v[88:91], v[184:187], v[120:123], 0
    ds_read_b128 v[152:155], v65 offset:128
    ds_read_b64 v[200:201], v64 offset:2048
    s_waitcnt lgkmcnt(14)
    v_mfma_f32_16x16x32_bf16 v[92:95], v[184:187], v[124:127], 0
    ds_read_b64 v[202:203], v64 offset:2056
    s_waitcnt lgkmcnt(12)
    v_mfma_f32_16x16x32_bf16 v[96:99], v[184:187], v[128:131], 0
    ds_read_b64 v[204:205], v64 offset:2560
    s_waitcnt lgkmcnt(10)
    v_mfma_f32_16x16x32_bf16 v[100:103], v[184:187], v[132:135], 0
    ds_read_b128 v[156:159], v65 offset:640
    ds_read_b64 v[206:207], v64 offset:2568
    s_waitcnt lgkmcnt(9)
    v_mfma_f32_16x16x32_bf16 v[104:107], v[184:187], v[136:139], 0
    ds_read_b64 v[208:209], v64 offset:3072
    s_waitcnt lgkmcnt(9)
    v_mfma_f32_16x16x32_bf16 v[108:111], v[184:187], v[140:143], 0
    ds_read_b64 v[210:211], v64 offset:3080
    s_waitcnt lgkmcnt(9)
    v_mfma_f32_16x16x32_bf16 v[112:115], v[184:187], v[144:147], 0
    ds_read_b128 v[160:163], v65 offset:1152
    ds_read_b64 v[212:213], v64 offset:3584
    s_waitcnt vmcnt(0)
    s_mov_b64 exec, 1
    buffer_store_dword v22, v23, s[56:59], 0 offen offset:16 sc1
    s_mov_b64 exec, -1
    s_waitcnt lgkmcnt(10)
    v_mfma_f32_16x16x32_bf16 v[116:119], v[184:187], v[148:151], 0
    ds_read_b64 v[214:215], v64 offset:3592
    ds_read_b64 v[184:185], v64 offset:64
    ds_read_b64 v[186:187], v64 offset:72
    ds_read_b64_tr_b16 a[32:33], v21 offset:32768
    v_mfma_f32_16x16x32_bf16 v[92:95], v[188:191], v[120:123], v[92:95]
    ds_read_b128 v[164:167], v65 offset:1664
    ds_read_b64_tr_b16 a[34:35], v21 offset:33792
    v_mfma_f32_16x16x32_bf16 v[96:99], v[188:191], v[124:127], v[96:99]
    ds_read_b64_tr_b16 a[36:37], v0 offset:32768
    v_mfma_f32_16x16x32_bf16 v[100:103], v[188:191], v[128:131], v[100:103]
    ds_read_b64_tr_b16 a[38:39], v0 offset:33792
    v_mfma_f32_16x16x32_bf16 v[104:107], v[188:191], v[132:135], v[104:107]
    ds_read_b128 v[168:171], v65 offset:2176
    ds_read_b64_tr_b16 a[40:41], v21 offset:34816
    v_mfma_f32_16x16x32_bf16 v[108:111], v[188:191], v[136:139], v[108:111]
    ds_read_b64_tr_b16 a[42:43], v21 offset:35840
    v_mfma_f32_16x16x32_bf16 v[112:115], v[188:191], v[140:143], v[112:115]
    ds_read_b64_tr_b16 a[44:45], v0 offset:34816
    v_mfma_f32_16x16x32_bf16 v[116:119], v[188:191], v[144:147], v[116:119]
    ds_read_b128 v[172:175], v65 offset:2688
    ds_read_b64 v[188:189], v64 offset:576
    ds_read_b64 v[190:191], v64 offset:584
    ds_read_b64_tr_b16 a[46:47], v0 offset:35840
    v_mfma_f32_16x16x32_bf16 v[96:99], v[192:195], v[120:123], v[96:99]
    ds_read_b128 v[176:179], v65 offset:3200
    ds_read_b64_tr_b16 a[48:49], v21 offset:36864
    v_mfma_f32_16x16x32_bf16 v[100:103], v[192:195], v[124:127], v[100:103]
    ds_read_b64_tr_b16 a[50:51], v21 offset:37888
    v_mfma_f32_16x16x32_bf16 v[104:107], v[192:195], v[128:131], v[104:107]
    ds_read_b64_tr_b16 a[52:53], v0 offset:36864
    v_mfma_f32_16x16x32_bf16 v[108:111], v[192:195], v[132:135], v[108:111]
    ds_read_b128 v[180:183], v65 offset:3712
    ds_read_b64_tr_b16 a[54:55], v0 offset:37888
    v_mfma_f32_16x16x32_bf16 v[112:115], v[192:195], v[136:139], v[112:115]
    ds_read_b64_tr_b16 a[56:57], v21 offset:38912
    v_mfma_f32_16x16x32_bf16 v[116:119], v[192:195], v[140:143], v[116:119]
    ds_read_b64 v[192:193], v64 offset:1088
    ds_read_b64 v[194:195], v64 offset:1096
    ds_read_b64_tr_b16 a[58:59], v21 offset:39936
    v_mfma_f32_16x16x32_bf16 v[100:103], v[196:199], v[120:123], v[100:103]
    ds_read_b64_tr_b16 a[60:61], v0 offset:38912
    v_mfma_f32_16x16x32_bf16 v[104:107], v[196:199], v[124:127], v[104:107]
    ds_read_b64_tr_b16 a[62:63], v0 offset:39936
    v_mfma_f32_16x16x32_bf16 v[108:111], v[196:199], v[128:131], v[108:111]
    s_waitcnt lgkmcnt(0)
    s_lshl_b32 s3, s77, 4
    s_add_u32 m0, s19, 32768
    s_nop 0
    buffer_load_dwordx4 v16, s[48:51], s3 offen offset:0 lds
    v_mfma_f32_16x16x32_bf16 v[112:115], v[196:199], v[132:135], v[112:115]
    buffer_load_dwordx4 v17, s[48:51], s3 offen offset:1024 lds
    v_mfma_f32_16x16x32_bf16 v[116:119], v[196:199], v[136:139], v[116:119]
    ds_read_b64 v[196:197], v64 offset:1600
    ds_read_b64 v[198:199], v64 offset:1608
    s_add_u32 m0, s19, 32768
    s_nop 0
    buffer_load_dwordx4 v20, s[48:51], s3 offen offset:2048 lds
    v_mfma_f32_16x16x32_bf16 v[104:107], v[200:203], v[120:123], v[104:107]
    buffer_load_dwordx4 v24, s[48:51], s3 offen offset:3072 lds
    v_mfma_f32_16x16x32_bf16 v[108:111], v[200:203], v[124:127], v[108:111]
    s_add_u32 s3, s3, 32768
    s_add_u32 m0, s19, 36864
    s_nop 0
    buffer_load_dwordx4 v16, s[48:51], s3 offen offset:0 lds
    v_mfma_f32_16x16x32_bf16 v[112:115], v[200:203], v[128:131], v[112:115]
    buffer_load_dwordx4 v17, s[48:51], s3 offen offset:1024 lds
    v_mfma_f32_16x16x32_bf16 v[116:119], v[200:203], v[132:135], v[116:119]
    ds_read_b64 v[200:201], v64 offset:2112
    ds_read_b64 v[202:203], v64 offset:2120
    s_add_u32 m0, s19, 36864
    s_nop 0
    buffer_load_dwordx4 v20, s[48:51], s3 offen offset:2048 lds
    v_mfma_f32_16x16x32_bf16 v[108:111], v[204:207], v[120:123], v[108:111]
    buffer_load_dwordx4 v24, s[48:51], s3 offen offset:3072 lds
    v_mfma_f32_16x16x32_bf16 v[112:115], v[204:207], v[124:127], v[112:115]
    ds_read_b64_tr_b16 a[64:65], v14 offset:0
    v_mfma_f32_16x16x32_bf16 v[116:119], v[204:207], v[128:131], v[116:119]
    ds_read_b64 v[204:205], v64 offset:2624
    ds_read_b64 v[206:207], v64 offset:2632
    ds_read_b64_tr_b16 a[66:67], v14 offset:1024
    v_mfma_f32_16x16x32_bf16 v[112:115], v[208:211], v[120:123], v[112:115]
    ds_read_b64_tr_b16 a[68:69], v15 offset:0
    v_mfma_f32_16x16x32_bf16 v[116:119], v[208:211], v[124:127], v[116:119]
    ds_read_b64 v[208:209], v64 offset:3136
    ds_read_b64 v[210:211], v64 offset:3144
    ds_read_b64_tr_b16 a[70:71], v15 offset:1024
    v_mfma_f32_16x16x32_bf16 v[116:119], v[212:215], v[120:123], v[116:119]
    ds_read_b64 v[212:213], v64 offset:3648
    ds_read_b64 v[214:215], v64 offset:3656
    ds_read_b64_tr_b16 a[72:73], v14 offset:2048
    v_mfma_f32_16x16x32_bf16 v[88:91], v[184:187], v[152:155], v[88:91]
    ds_read_b128 v[120:123], v65 offset:64
    ds_read_b64_tr_b16 a[74:75], v14 offset:3072
    v_mfma_f32_16x16x32_bf16 v[92:95], v[184:187], v[156:159], v[92:95]
    ds_read_b64_tr_b16 a[76:77], v15 offset:2048
    v_mfma_f32_16x16x32_bf16 v[96:99], v[184:187], v[160:163], v[96:99]
    ds_read_b64_tr_b16 a[78:79], v15 offset:3072
    v_mfma_f32_16x16x32_bf16 v[100:103], v[184:187], v[164:167], v[100:103]
    ds_read_b128 v[124:127], v65 offset:576
    ds_read_b64_tr_b16 a[80:81], v14 offset:4096
    v_mfma_f32_16x16x32_bf16 v[104:107], v[184:187], v[168:171], v[104:107]
    ds_read_b64_tr_b16 a[82:83], v14 offset:5120
    v_mfma_f32_16x16x32_bf16 v[108:111], v[184:187], v[172:175], v[108:111]
    ds_read_b64_tr_b16 a[84:85], v15 offset:4096
    v_mfma_f32_16x16x32_bf16 v[112:115], v[184:187], v[176:179], v[112:115]
    ds_read_b128 v[128:131], v65 offset:1088
    ds_read_b64_tr_b16 a[86:87], v15 offset:5120
    v_mfma_f32_16x16x32_bf16 v[116:119], v[184:187], v[180:183], v[116:119]
    ds_read_b64 v[184:185], v64 offset:128
    ds_read_b64 v[186:187], v64 offset:136
    ds_read_b64_tr_b16 a[88:89], v14 offset:6144
    v_mfma_f32_16x16x32_bf16 v[92:95], v[188:191], v[152:155], v[92:95]
    ds_read_b128 v[132:135], v65 offset:1600
    ds_read_b64_tr_b16 a[90:91], v14 offset:7168
    v_mfma_f32_16x16x32_bf16 v[96:99], v[188:191], v[156:159], v[96:99]
    ds_read_b64_tr_b16 a[92:93], v15 offset:6144
    v_mfma_f32_16x16x32_bf16 v[100:103], v[188:191], v[160:163], v[100:103]
    ds_read_b64_tr_b16 a[94:95], v15 offset:7168
    v_mfma_f32_16x16x32_bf16 v[104:107], v[188:191], v[164:167], v[104:107]
    ds_read_b128 v[136:139], v65 offset:2112
    s_waitcnt lgkmcnt(1)
    s_lshl_b32 s3, s78, 4
    s_add_u32 m0, s19, 65536
    s_nop 0
    buffer_load_dwordx4 v16, s[48:51], s3 offen offset:0 lds
    v_mfma_f32_16x16x32_bf16 v[108:111], v[188:191], v[168:171], v[108:111]
    buffer_load_dwordx4 v17, s[48:51], s3 offen offset:1024 lds
    v_mfma_f32_16x16x32_bf16 v[112:115], v[188:191], v[172:175], v[112:115]
    s_add_u32 m0, s19, 65536
    s_nop 0
    buffer_load_dwordx4 v20, s[48:51], s3 offen offset:2048 lds
    v_mfma_f32_16x16x32_bf16 v[116:119], v[188:191], v[176:179], v[116:119]
    ds_read_b128 v[140:143], v65 offset:2624
    ds_read_b64 v[188:189], v64 offset:640
    ds_read_b64 v[190:191], v64 offset:648
    buffer_load_dwordx4 v24, s[48:51], s3 offen offset:3072 lds
    v_mfma_f32_16x16x32_bf16 v[96:99], v[192:195], v[152:155], v[96:99]
    ds_read_b128 v[144:147], v65 offset:3136
    s_add_u32 s3, s3, 32768
    s_add_u32 m0, s19, 69632
    s_nop 0
    buffer_load_dwordx4 v16, s[48:51], s3 offen offset:0 lds
    v_mfma_f32_16x16x32_bf16 v[100:103], v[192:195], v[156:159], v[100:103]
    buffer_load_dwordx4 v17, s[48:51], s3 offen offset:1024 lds
    v_mfma_f32_16x16x32_bf16 v[104:107], v[192:195], v[160:163], v[104:107]
    s_add_u32 m0, s19, 69632
    s_nop 0
    buffer_load_dwordx4 v20, s[48:51], s3 offen offset:2048 lds
    v_mfma_f32_16x16x32_bf16 v[108:111], v[192:195], v[164:167], v[108:111]
    ds_read_b128 v[148:151], v65 offset:3648
    buffer_load_dwordx4 v24, s[48:51], s3 offen offset:3072 lds
    v_mfma_f32_16x16x32_bf16 v[112:115], v[192:195], v[168:171], v[112:115]
    ds_read_b64_tr_b16 a[96:97], v21 offset:0
    v_mfma_f32_16x16x32_bf16 v[116:119], v[192:195], v[172:175], v[116:119]
    ds_read_b64 v[192:193], v64 offset:1152
    ds_read_b64 v[194:195], v64 offset:1160
    ds_read_b64_tr_b16 a[98:99], v21 offset:1024
    v_mfma_f32_16x16x32_bf16 v[100:103], v[196:199], v[152:155], v[100:103]
    ds_read_b64_tr_b16 a[100:101], v0 offset:0
    v_mfma_f32_16x16x32_bf16 v[104:107], v[196:199], v[156:159], v[104:107]
    ds_read_b64_tr_b16 a[102:103], v0 offset:1024
    v_mfma_f32_16x16x32_bf16 v[108:111], v[196:199], v[160:163], v[108:111]
    ds_read_b64_tr_b16 a[104:105], v21 offset:2048
    v_mfma_f32_16x16x32_bf16 v[112:115], v[196:199], v[164:167], v[112:115]
    ds_read_b64_tr_b16 a[106:107], v21 offset:3072
    v_mfma_f32_16x16x32_bf16 v[116:119], v[196:199], v[168:171], v[116:119]
    ds_read_b64 v[196:197], v64 offset:1664
    ds_read_b64 v[198:199], v64 offset:1672
    ds_read_b64_tr_b16 a[108:109], v0 offset:2048
    v_mfma_f32_16x16x32_bf16 v[104:107], v[200:203], v[152:155], v[104:107]
    ds_read_b64_tr_b16 a[110:111], v0 offset:3072
    v_mfma_f32_16x16x32_bf16 v[108:111], v[200:203], v[156:159], v[108:111]
    ds_read_b64_tr_b16 a[112:113], v21 offset:4096
    v_mfma_f32_16x16x32_bf16 v[112:115], v[200:203], v[160:163], v[112:115]
    ds_read_b64_tr_b16 a[114:115], v21 offset:5120
    v_mfma_f32_16x16x32_bf16 v[116:119], v[200:203], v[164:167], v[116:119]
    ds_read_b64 v[200:201], v64 offset:2176
    ds_read_b64 v[202:203], v64 offset:2184
    ds_read_b64_tr_b16 a[116:117], v0 offset:4096
    v_mfma_f32_16x16x32_bf16 v[108:111], v[204:207], v[152:155], v[108:111]
    ds_read_b64_tr_b16 a[118:119], v0 offset:5120
    v_mfma_f32_16x16x32_bf16 v[112:115], v[204:207], v[156:159], v[112:115]
    ds_read_b64_tr_b16 a[120:121], v21 offset:6144
    v_mfma_f32_16x16x32_bf16 v[116:119], v[204:207], v[160:163], v[116:119]
    ds_read_b64 v[204:205], v64 offset:2688
    ds_read_b64 v[206:207], v64 offset:2696
    ds_read_b64_tr_b16 a[122:123], v21 offset:7168
    v_mfma_f32_16x16x32_bf16 v[112:115], v[208:211], v[152:155], v[112:115]
    ds_read_b64_tr_b16 a[124:125], v0 offset:6144
    v_mfma_f32_16x16x32_bf16 v[116:119], v[208:211], v[156:159], v[116:119]
    ds_read_b64 v[208:209], v64 offset:3200
    ds_read_b64 v[210:211], v64 offset:3208
    ds_read_b64_tr_b16 a[126:127], v0 offset:7168
    v_mfma_f32_16x16x32_bf16 v[116:119], v[212:215], v[152:155], v[116:119]
    ds_read_b64 v[212:213], v64 offset:3712
    ds_read_b64 v[214:215], v64 offset:3720
    s_waitcnt lgkmcnt(2)
    s_lshl_b32 s3, s79, 4
    s_add_u32 m0, s19, 0
    s_nop 0
    buffer_load_dwordx4 v16, s[48:51], s3 offen offset:0 lds
    v_mfma_f32_16x16x32_bf16 v[88:91], v[184:187], v[120:123], v[88:91]
    ds_read_b128 v[152:155], v65 offset:0
    buffer_load_dwordx4 v17, s[48:51], s3 offen offset:1024 lds
    v_mfma_f32_16x16x32_bf16 v[92:95], v[184:187], v[124:127], v[92:95]
    v_and_b32 v26, 31, v1
    s_add_u32 m0, s19, 0
    s_nop 0
    buffer_load_dwordx4 v20, s[48:51], s3 offen offset:2048 lds
    v_mfma_f32_16x16x32_bf16 v[96:99], v[184:187], v[128:131], v[96:99]
    v_lshrrev_b32 v27, 5, v1
    v_mfma_f32_16x16x32_bf16 v[100:103], v[184:187], v[132:135], v[100:103]
    ds_read_b128 v[156:159], v65 offset:512
    buffer_load_dwordx4 v24, s[48:51], s3 offen offset:3072 lds
    v_mfma_f32_16x16x32_bf16 v[104:107], v[184:187], v[136:139], v[104:107]
    v_and_b32 v28, 7, v1
    s_add_u32 s3, s3, 32768
    s_add_u32 m0, s19, 4096
    s_nop 0
    buffer_load_dwordx4 v16, s[48:51], s3 offen offset:0 lds
    v_mfma_f32_16x16x32_bf16 v[108:111], v[184:187], v[140:143], v[108:111]
    v_xor_b32 v27, v27, v28
    buffer_load_dwordx4 v17, s[48:51], s3 offen offset:1024 lds
    v_mfma_f32_16x16x32_bf16 v[112:115], v[184:187], v[144:147], v[112:115]
    ds_read_b128 v[160:163], v65 offset:1024
    s_add_u32 m0, s19, 4096
    s_nop 0
    buffer_load_dwordx4 v20, s[48:51], s3 offen offset:2048 lds
    v_mfma_f32_16x16x32_bf16 v[116:119], v[184:187], v[148:151], v[116:119]
    ds_read_b64 v[184:185], v64 offset:192
    ds_read_b64 v[186:187], v64 offset:200
    buffer_load_dwordx4 v24, s[48:51], s3 offen offset:3072 lds
    v_mfma_f32_16x16x32_bf16 v[92:95], v[188:191], v[120:123], v[92:95]
    ds_read_b128 v[164:167], v65 offset:1536
    s_waitcnt vmcnt(16)
    ds_read_b64_tr_b16 a[128:129], v21 offset:32768
    v_mfma_f32_16x16x32_bf16 v[96:99], v[188:191], v[124:127], v[96:99]
    v_lshlrev_b32 v27, 4, v27
    ds_read_b64_tr_b16 a[130:131], v21 offset:33792
    v_mfma_f32_16x16x32_bf16 v[100:103], v[188:191], v[128:131], v[100:103]
    v_lshl_add_u32 v26, v26, 8, v27
    ds_read_b64_tr_b16 a[132:133], v0 offset:32768
    v_mfma_f32_16x16x32_bf16 v[104:107], v[188:191], v[132:135], v[104:107]
    ds_read_b128 v[168:171], v65 offset:2048
    ds_read_b64_tr_b16 a[134:135], v0 offset:33792
    v_mfma_f32_16x16x32_bf16 v[108:111], v[188:191], v[136:139], v[108:111]
    s_lshl_b32 s64, s61, 13
    ds_read_b64_tr_b16 a[136:137], v21 offset:34816
    v_mfma_f32_16x16x32_bf16 v[112:115], v[188:191], v[140:143], v[112:115]
    v_add_u32 v2, s64, v26
    ds_read_b64_tr_b16 a[138:139], v21 offset:35840
    v_mfma_f32_16x16x32_bf16 v[116:119], v[188:191], v[144:147], v[116:119]
    ds_read_b128 v[172:175], v65 offset:2560
    ds_read_b64 v[188:189], v64 offset:704
    ds_read_b64 v[190:191], v64 offset:712
    ds_read_b64_tr_b16 a[140:141], v0 offset:34816
    v_mfma_f32_16x16x32_bf16 v[96:99], v[192:195], v[120:123], v[96:99]
    ds_read_b128 v[176:179], v65 offset:3072
    ds_read_b64_tr_b16 a[142:143], v0 offset:35840
    v_mfma_f32_16x16x32_bf16 v[100:103], v[192:195], v[124:127], v[100:103]
    v_xor_b32 v3, 32, v2
    ds_read_b64_tr_b16 a[144:145], v21 offset:36864
    v_mfma_f32_16x16x32_bf16 v[104:107], v[192:195], v[128:131], v[104:107]
    v_xor_b32 v4, 64, v2
    ds_read_b64_tr_b16 a[146:147], v21 offset:37888
    v_mfma_f32_16x16x32_bf16 v[108:111], v[192:195], v[132:135], v[108:111]
    ds_read_b128 v[180:183], v65 offset:3584
    ds_read_b64_tr_b16 a[148:149], v0 offset:36864
    v_mfma_f32_16x16x32_bf16 v[112:115], v[192:195], v[136:139], v[112:115]
    v_xor_b32 v5, 96, v2
    ds_read_b64_tr_b16 a[150:151], v0 offset:37888
    v_mfma_f32_16x16x32_bf16 v[116:119], v[192:195], v[140:143], v[116:119]
    ds_read_b64 v[192:193], v64 offset:1216
    ds_read_b64 v[194:195], v64 offset:1224
    ds_read_b64_tr_b16 a[152:153], v21 offset:38912
    v_mfma_f32_16x16x32_bf16 v[100:103], v[196:199], v[120:123], v[100:103]
    v_lshrrev_b32 v26, 3, v1
    ds_read_b64_tr_b16 a[154:155], v21 offset:39936
    v_mfma_f32_16x16x32_bf16 v[104:107], v[196:199], v[124:127], v[104:107]
    v_lshlrev_b32 v27, 1, v28
    ds_read_b64_tr_b16 a[156:157], v0 offset:38912
    v_mfma_f32_16x16x32_bf16 v[108:111], v[196:199], v[128:131], v[108:111]
    v_xor_b32 v27, v27, v26
    ds_read_b64_tr_b16 a[158:159], v0 offset:39936
    v_mfma_f32_16x16x32_bf16 v[112:115], v[196:199], v[132:135], v[112:115]
    v_lshlrev_b32 v27, 4, v27
    s_waitcnt vmcnt(8)
    ds_read_b64_tr_b16 a[160:161], v14 offset:0
    v_mfma_f32_16x16x32_bf16 v[116:119], v[196:199], v[136:139], v[116:119]
    ds_read_b64 v[196:197], v64 offset:1728
    ds_read_b64 v[198:199], v64 offset:1736
    ds_read_b64_tr_b16 a[162:163], v14 offset:1024
    v_mfma_f32_16x16x32_bf16 v[104:107], v[200:203], v[120:123], v[104:107]
    v_lshl_add_u32 v27, v26, 8, v27
    ds_read_b64_tr_b16 a[164:165], v15 offset:0
    v_mfma_f32_16x16x32_bf16 v[108:111], v[200:203], v[124:127], v[108:111]
    s_lshl_b32 s64, s61, 11
    ds_read_b64_tr_b16 a[166:167], v15 offset:1024
    v_mfma_f32_16x16x32_bf16 v[112:115], v[200:203], v[128:131], v[112:115]
    v_add_u32 v6, s64, v27
    ds_read_b64_tr_b16 a[168:169], v14 offset:2048
    v_mfma_f32_16x16x32_bf16 v[116:119], v[200:203], v[132:135], v[116:119]
    ds_read_b64 v[200:201], v64 offset:2240
    ds_read_b64 v[202:203], v64 offset:2248
    ds_read_b64_tr_b16 a[170:171], v14 offset:3072
    v_mfma_f32_16x16x32_bf16 v[108:111], v[204:207], v[120:123], v[108:111]
    v_xor_b32 v7, 16, v6
    ds_read_b64_tr_b16 a[172:173], v15 offset:2048
    v_mfma_f32_16x16x32_bf16 v[112:115], v[204:207], v[124:127], v[112:115]
    v_mul_u32_u24 v12, 1040, v28
    ds_read_b64_tr_b16 a[174:175], v15 offset:3072
    v_mfma_f32_16x16x32_bf16 v[116:119], v[204:207], v[128:131], v[116:119]
    ds_read_b64 v[204:205], v64 offset:2752
    ds_read_b64 v[206:207], v64 offset:2760
    buffer_load_dword v25, v74, s[56:59], 0 offen sc1
    v_mfma_f32_16x16x32_bf16 v[112:115], v[208:211], v[120:123], v[112:115]
    v_lshl_add_u32 v12, v26, 1, v12
    ds_read_b64_tr_b16 a[176:177], v14 offset:4096
    v_mfma_f32_16x16x32_bf16 v[116:119], v[208:211], v[124:127], v[116:119]
    ds_read_b64 v[208:209], v64 offset:3264
    ds_read_b64 v[210:211], v64 offset:3272
    ds_read_b64_tr_b16 a[178:179], v14 offset:5120
    s_waitcnt lgkmcnt(15)
    v_mfma_f32_16x16x32_bf16 v[116:119], v[212:215], v[120:123], v[116:119]
    ds_read_b64 v[212:213], v64 offset:3776
    ds_read_b64 v[214:215], v64 offset:3784
    ds_read_b64_tr_b16 a[180:181], v15 offset:4096
    v_mfma_f32_16x16x32_bf16 v[88:91], v[184:187], v[152:155], v[88:91]
    s_lshl_b32 s64, s18, 6
    ds_read_b64_tr_b16 a[182:183], v15 offset:5120
    v_mfma_f32_16x16x32_bf16 v[92:95], v[184:187], v[156:159], v[92:95]
    s_lshl_b32 s65, s17, 4
    ds_read_b64_tr_b16 a[184:185], v14 offset:6144
    v_mfma_f32_16x16x32_bf16 v[96:99], v[184:187], v[160:163], v[96:99]
    s_add_u32 s64, s64, s65
    ds_read_b64_tr_b16 a[186:187], v14 offset:7168
    v_mfma_f32_16x16x32_bf16 v[100:103], v[184:187], v[164:167], v[100:103]
    s_add_u32 s64, s64, 106496
    ds_read_b64_tr_b16 a[188:189], v15 offset:6144
    v_mfma_f32_16x16x32_bf16 v[104:107], v[184:187], v[168:171], v[104:107]
    v_add_u32 v12, s64, v12
    ds_read_b64_tr_b16 a[190:191], v15 offset:7168
    v_mfma_f32_16x16x32_bf16 v[108:111], v[184:187], v[172:175], v[108:111]
    v_lshl_add_u32 v13, v1, 4, s8
    s_mov_b32 m0, s8
    s_nop 0
    buffer_load_dwordx4 v81, s[28:31], s7 offen lds
    s_add_u32 s7, s7, 31744
    buffer_load_dwordx4 v81, s[28:31], s7 offen offset:1024 lds
    v_mfma_f32_16x16x32_bf16 v[112:115], v[184:187], v[176:179], v[112:115]
    v_mov_b32 v60, 0xbfb8aa3b
    s_waitcnt vmcnt(3)
    ds_read_b64_tr_b16 a[192:193], v21 offset:0
    v_mfma_f32_16x16x32_bf16 v[116:119], v[184:187], v[180:183], v[116:119]
    v_cmp_ne_u32 vcc, s60, v43
    s_nop 4
    s_cbranch_vccz L_ok_7
    s_mov_b32 s96, 200000
L_spin_8:
    s_sleep 2
    buffer_load_dwordx2 v[42:43], v80, s[56:59], 0 offen sc1
    s_waitcnt vmcnt(0)
    s_sub_u32 s96, s96, 1
    s_cbranch_scc1 L_ok_7
    v_cmp_ne_u32 vcc, s60, v43
    s_nop 4
    s_cbranch_vccnz L_spin_8
L_ok_7:
    ds_read_b64_tr_b16 a[194:195], v21 offset:1024
    v_mfma_f32_16x16x32_bf16 v[92:95], v[188:191], v[152:155], v[92:95]
    v_mov_b32_dpp v40, v42 quad_perm:[0,0,2,2] row_mask:0xf bank_mask:0xf bound_ctrl:1
    ds_read_b64_tr_b16 a[196:197], v0 offset:0
    v_mfma_f32_16x16x32_bf16 v[96:99], v[188:191], v[156:159], v[96:99]
    v_mov_b32_dpp v42, v42 quad_perm:[1,1,3,3] row_mask:0xf bank_mask:0xf bound_ctrl:1
    ds_read_b64_tr_b16 a[198:199], v0 offset:1024
    v_mfma_f32_16x16x32_bf16 v[100:103], v[188:191], v[160:163], v[100:103]
    v_lshlrev_b32 v41, 16, v40
    ds_read_b64_tr_b16 a[200:201], v21 offset:2048
    v_mfma_f32_16x16x32_bf16 v[104:107], v[188:191], v[164:167], v[104:107]
    v_and_b32 v40, 0xffff0000, v40
    ds_read_b64_tr_b16 a[202:203], v21 offset:3072
    v_mfma_f32_16x16x32_bf16 v[108:111], v[188:191], v[168:171], v[108:111]
    v_rcp_f32 v41, v41
    ds_read_b64_tr_b16 a[204:205], v0 offset:2048
    v_mfma_f32_16x16x32_bf16 v[112:115], v[188:191], v[172:175], v[112:115]
    v_lshlrev_b32 v43, 16, v42
    ds_read_b64_tr_b16 a[206:207], v0 offset:3072
    v_mfma_f32_16x16x32_bf16 v[116:119], v[188:191], v[176:179], v[116:119]
    v_and_b32 v42, 0xffff0000, v42
    ds_read_b64_tr_b16 a[208:209], v21 offset:4096
    v_mfma_f32_16x16x32_bf16 v[96:99], v[192:195], v[152:155], v[96:99]
    v_rcp_f32 v43, v43
    ds_read_b64_tr_b16 a[210:211], v21 offset:5120
    v_mfma_f32_16x16x32_bf16 v[100:103], v[192:195], v[156:159], v[100:103]
    ds_read_b64_tr_b16 a[212:213], v0 offset:4096
    v_mfma_f32_16x16x32_bf16 v[104:107], v[192:195], v[160:163], v[104:107]
    ds_read_b64_tr_b16 a[214:215], v0 offset:5120
    v_mfma_f32_16x16x32_bf16 v[108:111], v[192:195], v[164:167], v[108:111]
    ds_read_b64_tr_b16 a[216:217], v21 offset:6144
    v_mfma_f32_16x16x32_bf16 v[112:115], v[192:195], v[168:171], v[112:115]
    ds_read_b64_tr_b16 a[218:219], v21 offset:7168
    v_mfma_f32_16x16x32_bf16 v[116:119], v[192:195], v[172:175], v[116:119]
    ds_read_b64_tr_b16 a[220:221], v0 offset:6144
    v_mfma_f32_16x16x32_bf16 v[100:103], v[196:199], v[152:155], v[100:103]
    ds_read_b64_tr_b16 a[222:223], v0 offset:7168
    v_mfma_f32_16x16x32_bf16 v[104:107], v[196:199], v[156:159], v[104:107]
    s_waitcnt vmcnt(2)
    v_cmp_ne_u32 vcc, s60, v25
    s_nop 4
    s_cbranch_vccz L_ok_9
    s_mov_b32 s96, 200000
L_spin_10:
    s_sleep 2
    buffer_load_dword v25, v74, s[56:59], 0 offen sc1
    s_waitcnt vmcnt(0)
    s_sub_u32 s96, s96, 1
    s_cbranch_scc1 L_ok_9
    v_cmp_ne_u32 vcc, s60, v25
    s_nop 4
    s_cbranch_vccnz L_spin_10
L_ok_9:
    v_mfma_f32_16x16x32_bf16 v[108:111], v[196:199], v[160:163], v[108:111]
    buffer_load_dwordx4 v[216:219], v72, s[56:59], s73 offen offset:0 sc1
    v_mfma_f32_16x16x32_bf16 v[112:115], v[196:199], v[164:167], v[112:115]
    buffer_load_dwordx4 v[220:223], v72, s[56:59], s73 offen offset:1024 sc1
    v_mfma_f32_16x16x32_bf16 v[116:119], v[196:199], v[168:171], v[116:119]
    buffer_load_dwordx4 v[224:227], v72, s[56:59], s73 offen offset:2048 sc1
    s_waitcnt lgkmcnt(15)
    v_mfma_f32_16x16x32_bf16 v[104:107], v[200:203], v[152:155], v[104:107]
    buffer_load_dwordx4 v[228:231], v72, s[56:59], s73 offen offset:3072 sc1
    v_mfma_f32_16x16x32_bf16 v[108:111], v[200:203], v[156:159], v[108:111]
    buffer_load_dwordx4 v[232:235], v72, s[56:59], s74 offen offset:0 sc1
    v_mfma_f32_16x16x32_bf16 v[112:115], v[200:203], v[160:163], v[112:115]
    buffer_load_dwordx4 v[236:239], v72, s[56:59], s74 offen offset:1024 sc1
    v_mfma_f32_16x16x32_bf16 v[116:119], v[200:203], v[164:167], v[116:119]
    buffer_load_dwordx4 v[240:243], v72, s[56:59], s74 offen offset:2048 sc1
    v_mfma_f32_16x16x32_bf16 v[108:111], v[204:207], v[152:155], v[108:111]
    buffer_load_dwordx4 v[244:247], v72, s[56:59], s74 offen offset:3072 sc1
    v_mfma_f32_16x16x32_bf16 v[112:115], v[204:207], v[156:159], v[112:115]
    buffer_load_dwordx4 v[248:251], v72, s[56:59], s75 offen offset:0 sc1
    v_mfma_f32_16x16x32_bf16 v[116:119], v[204:207], v[160:163], v[116:119]
    buffer_load_dwordx4 v[252:255], v72, s[56:59], s75 offen offset:1024 sc1
    v_mfma_f32_16x16x32_bf16 v[112:115], v[208:211], v[152:155], v[112:115]
    buffer_load_dwordx4 a[224:227], v72, s[56:59], s75 offen offset:2048 sc1
    v_mfma_f32_16x16x32_bf16 v[116:119], v[208:211], v[156:159], v[116:119]
    buffer_load_dwordx4 a[228:231], v72, s[56:59], s75 offen offset:3072 sc1
    v_mfma_f32_16x16x32_bf16 v[116:119], v[212:215], v[152:155], v[116:119]
    buffer_load_dwordx4 a[232:235], v72, s[56:59], s76 offen offset:0 sc1
    buffer_load_dwordx4 a[236:239], v72, s[56:59], s76 offen offset:1024 sc1
    buffer_load_dwordx4 a[240:243], v72, s[56:59], s76 offen offset:2048 sc1
    buffer_load_dwordx4 a[244:247], v72, s[56:59], s76 offen offset:3072 sc1
    buffer_load_dwordx4 a[248:251], v72, s[56:59], s77 offen offset:0 sc1
    buffer_load_dwordx4 a[252:255], v72, s[56:59], s77 offen offset:1024 sc1
    s_waitcnt lgkmcnt(0)
    s_waitcnt vmcnt(17)
    v_mfma_f32_32x32x16_bf16 v[152:167], a[0:3], v[216:219], 0
    v_mfma_f32_32x32x16_bf16 v[168:183], a[4:7], v[216:219], 0
    s_bitcmp1_b32 s61, 0
    s_cbranch_scc1 L_codd_11
    ds_write_b128 v84, v[104:107] offset:0
    v_mov_b64 v[136:137], v[88:89]
    v_mov_b64 v[138:139], v[90:91]
    s_branch L_cjoin_12
L_codd_11:
    ds_write_b128 v84, v[88:91] offset:0
    v_mov_b64 v[136:137], v[104:105]
    v_mov_b64 v[138:139], v[106:107]
L_cjoin_12:
    s_waitcnt vmcnt(16)
    v_mfma_f32_32x32x16_bf16 v[152:167], a[8:11], v[220:223], v[152:167]
    buffer_load_dwordx4 v[216:219], v72, s[56:59], s77 offen offset:2048 sc1
    s_bitcmp1_b32 s61, 0
    s_cbranch_scc1 L_codd_13
    ds_write_b128 v84, v[108:111] offset:1024
    v_mov_b64 v[140:141], v[92:93]
    v_mov_b64 v[142:143], v[94:95]
    s_branch L_cjoin_14
L_codd_13:
    ds_write_b128 v84, v[92:95] offset:1024
    v_mov_b64 v[140:141], v[108:109]
    v_mov_b64 v[142:143], v[110:111]
L_cjoin_14:
    v_mfma_f32_32x32x16_bf16 v[168:183], a[12:15], v[220:223], v[168:183]
    s_waitcnt vmcnt(16)
    v_mfma_f32_32x32x16_bf16 v[152:167], a[16:19], v[224:227], v[152:167]
    buffer_load_dwordx4 v[220:223], v72, s[56:59], s77 offen offset:3072 sc1
    s_bitcmp1_b32 s61, 0
    s_cbranch_scc1 L_codd_15
    ds_write_b128 v84, v[112:115] offset:2048
    v_mov_b64 v[144:145], v[96:97]
    v_mov_b64 v[146:147], v[98:99]
    s_branch L_cjoin_16
L_codd_15:
    ds_write_b128 v84, v[96:99] offset:2048
    v_mov_b64 v[144:145], v[112:113]
    v_mov_b64 v[146:147], v[114:115]
L_cjoin_16:
    v_mfma_f32_32x32x16_bf16 v[168:183], a[20:23], v[224:227], v[168:183]
    s_waitcnt vmcnt(16)
    v_mfma_f32_32x32x16_bf16 v[152:167], a[24:27], v[228:231], v[152:167]
    buffer_load_dwordx4 v[224:227], v72, s[56:59], s78 offen offset:0 sc1
    s_bitcmp1_b32 s61, 0
    s_cbranch_scc1 L_codd_17
    ds_write_b128 v84, v[116:119] offset:3072
    v_mov_b64 v[148:149], v[100:101]
    v_mov_b64 v[150:151], v[102:103]
    s_branch L_cjoin_18
L_codd_17:
    ds_write_b128 v84, v[100:103] offset:3072
    v_mov_b64 v[148:149], v[116:117]
    v_mov_b64 v[150:151], v[118:119]
L_cjoin_18:
    v_mfma_f32_32x32x16_bf16 v[168:183], a[28:31], v[228:231], v[168:183]
    s_waitcnt vmcnt(16)
    v_mfma_f32_32x32x16_bf16 v[152:167], a[32:35], v[232:235], v[152:167]
    buffer_load_dwordx4 v[228:231], v72, s[56:59], s78 offen offset:1024 sc1
    v_mfma_f32_32x32x16_bf16 v[168:183], a[36:39], v[232:235], v[168:183]
    s_waitcnt vmcnt(16)
    v_mfma_f32_32x32x16_bf16 v[152:167], a[40:43], v[236:239], v[152:167]
    buffer_load_dwordx4 v[232:235], v72, s[56:59], s78 offen offset:2048 sc1
    v_mfma_f32_32x32x16_bf16 v[168:183], a[44:47], v[236:239], v[168:183]
    s_waitcnt lgkmcnt(0)
    s_barrier
    ds_read_b64 v[96:97], v68 offset:0
    ds_read_b64 v[98:99], v68 offset:512
    ds_read_b64 v[100:101], v68 offset:1024
    ds_read_b64 v[102:103], v68 offset:1536
    ds_read_b128 v[120:123], v85 offset:0
    ds_read_b128 v[124:127], v85 offset:1024
    ds_read_b128 v[128:131], v85 offset:2048
    ds_read_b128 v[132:135], v85 offset:3072
    s_waitcnt vmcnt(16)
    v_mfma_f32_32x32x16_bf16 v[152:167], a[48:51], v[240:243], v[152:167]
    buffer_load_dwordx4 v[236:239], v72, s[56:59], s78 offen offset:3072 sc1
    v_mfma_f32_32x32x16_bf16 v[168:183], a[52:55], v[240:243], v[168:183]
    s_waitcnt vmcnt(16)
    v_mfma_f32_32x32x16_bf16 v[152:167], a[56:59], v[244:247], v[152:167]
    buffer_load_dwordx4 v[240:243], v72, s[56:59], s79 offen offset:0 sc1
    v_mfma_f32_32x32x16_bf16 v[168:183], a[60:63], v[244:247], v[168:183]
    s_waitcnt lgkmcnt(3)
    v_add_f32 v120, v120, v136
    v_add_f32 v121, v121, v137
    v_add_f32 v122, v122, v138
    v_add_f32 v123, v123, v139
    v_and_b32 v104, 0xffff0000, v97
    v_lshlrev_b32 v105, 16, v97
    v_and_b32 v106, 0xffff0000, v96
    v_lshlrev_b32 v107, 16, v96
    v_mul_f32 v104, s72, v104
    s_waitcnt vmcnt(16)
    v_mfma_f32_32x32x16_bf16 v[152:167], a[64:67], v[248:251], v[152:167]
    buffer_load_dwordx4 v[244:247], v72, s[56:59], s79 offen offset:1024 sc1
    v_mul_f32 v105, s72, v105
    v_mul_f32 v106, s72, v106
    v_mul_f32 v107, s72, v107
    v_cvt_pk_bf16_f32 v108, v104, v105
    v_cvt_pk_bf16_f32 v110, v120, v121
    v_cvt_pk_bf16_f32 v109, v106, v107
    v_cvt_pk_bf16_f32 v111, v122, v123
    v_lshlrev_b32 v104, 16, v108
    v_mfma_f32_32x32x16_bf16 v[168:183], a[68:71], v[248:251], v[168:183]
    v_and_b32 v105, 0xffff0000, v108
    v_lshlrev_b32 v120, 16, v110
    v_and_b32 v121, 0xffff0000, v110
    v_lshlrev_b32 v106, 16, v109
    v_and_b32 v107, 0xffff0000, v109
    v_lshlrev_b32 v122, 16, v111
    v_and_b32 v123, 0xffff0000, v111
    v_add_f32 v120, v120, v104
    v_add_f32 v121, v121, v105
    v_add_f32 v122, v122, v106
    s_waitcnt vmcnt(16)
    v_mfma_f32_32x32x16_bf16 v[152:167], a[72:75], v[252:255], v[152:167]
    buffer_load_dwordx4 v[248:251], v72, s[56:59], s79 offen offset:2048 sc1
    v_add_f32 v123, v123, v107
    v_cvt_pk_bf16_f32 v88, v120, v121
    v_cvt_pk_bf16_f32 v89, v122, v123
    s_waitcnt lgkmcnt(2)
    v_add_f32 v124, v124, v140
    v_add_f32 v125, v125, v141
    v_add_f32 v126, v126, v142
    v_add_f32 v127, v127, v143
    v_mfma_f32_32x32x16_bf16 v[168:183], a[76:79], v[252:255], v[168:183]
    v_and_b32 v104, 0xffff0000, v99
    v_lshlrev_b32 v105, 16, v99
    v_and_b32 v106, 0xffff0000, v98
    v_lshlrev_b32 v107, 16, v98
    v_mul_f32 v104, s72, v104
    v_mul_f32 v105, s72, v105
    v_mul_f32 v106, s72, v106
    v_mul_f32 v107, s72, v107
    v_cvt_pk_bf16_f32 v108, v104, v105
    v_cvt_pk_bf16_f32 v110, v124, v125
    s_waitcnt vmcnt(16)
    v_mfma_f32_32x32x16_bf16 v[152:167], a[80:83], a[224:227], v[152:167]
    buffer_load_dwordx4 v[252:255], v72, s[56:59], s79 offen offset:3072 sc1
    v_cvt_pk_bf16_f32 v109, v106, v107
    v_cvt_pk_bf16_f32 v111, v126, v127
    v_lshlrev_b32 v104, 16, v108
    v_and_b32 v105, 0xffff0000, v108
    v_lshlrev_b32 v124, 16, v110
    v_and_b32 v125, 0xffff0000, v110
    v_lshlrev_b32 v106, 16, v109
    v_and_b32 v107, 0xffff0000, v109
    v_mfma_f32_32x32x16_bf16 v[168:183], a[84:87], a[224:227], v[168:183]
    v_lshlrev_b32 v126, 16, v111
    v_and_b32 v127, 0xffff0000, v111
    v_add_f32 v124, v124, v104
    v_add_f32 v125, v125, v105
    v_add_f32 v126, v126, v106
    v_add_f32 v127, v127, v107
    v_cvt_pk_bf16_f32 v90, v124, v125
    v_cvt_pk_bf16_f32 v91, v126, v127
    s_waitcnt lgkmcnt(1)
    v_add_f32 v128, v128, v144
    s_waitcnt vmcnt(16)
    v_mfma_f32_32x32x16_bf16 v[152:167], a[88:91], a[228:231], v[152:167]
    buffer_load_dwordx4 a[224:227], v73, s[56:59], s73 offen offset:0 sc1
    v_add_f32 v129, v129, v145
    v_add_f32 v130, v130, v146
    v_add_f32 v131, v131, v147
    v_and_b32 v104, 0xffff0000, v101
    v_lshlrev_b32 v105, 16, v101
    v_and_b32 v106, 0xffff0000, v100
    v_lshlrev_b32 v107, 16, v100
    v_mul_f32 v104, s72, v104
    v_mfma_f32_32x32x16_bf16 v[168:183], a[92:95], a[228:231], v[168:183]
    v_mul_f32 v105, s72, v105
    v_mul_f32 v106, s72, v106
    v_mul_f32 v107, s72, v107
    v_cvt_pk_bf16_f32 v108, v104, v105
    v_cvt_pk_bf16_f32 v110, v128, v129
    v_cvt_pk_bf16_f32 v109, v106, v107
    v_cvt_pk_bf16_f32 v111, v130, v131
    v_lshlrev_b32 v104, 16, v108
    v_and_b32 v105, 0xffff0000, v108
    v_lshlrev_b32 v128, 16, v110
    s_waitcnt vmcnt(16)
    v_mfma_f32_32x32x16_bf16 v[152:167], a[96:99], a[232:235], v[152:167]
    buffer_load_dwordx4 a[228:231], v73, s[56:59], s73 offen offset:1024 sc1
    v_and_b32 v129, 0xffff0000, v110
    v_lshlrev_b32 v106, 16, v109
    v_and_b32 v107, 0xffff0000, v109
    v_lshlrev_b32 v130, 16, v111
    v_and_b32 v131, 0xffff0000, v111
    v_add_f32 v128, v128, v104
    v_add_f32 v129, v129, v105
    v_add_f32 v130, v130, v106
    v_mfma_f32_32x32x16_bf16 v[168:183], a[100:103], a[232:235], v[168:183]
    v_add_f32 v131, v131, v107
    v_cvt_pk_bf16_f32 v92, v128, v129
    v_cvt_pk_bf16_f32 v93, v130, v131
    s_waitcnt lgkmcnt(0)
    v_add_f32 v132, v132, v148
    v_add_f32 v133, v133, v149
    v_add_f32 v134, v134, v150
    v_add_f32 v135, v135, v151
    v_and_b32 v104, 0xffff0000, v103
    v_lshlrev_b32 v105, 16, v103
    s_waitcnt vmcnt(16)
    v_mfma_f32_32x32x16_bf16 v[152:167], a[104:107], a[236:239], v[152:167]
    buffer_load_dwordx4 a[232:235], v73, s[56:59], s73 offen offset:2048 sc1
    v_and_b32 v106, 0xffff0000, v102
    v_lshlrev_b32 v107, 16, v102
    v_mul_f32 v104, s72, v104
    v_mul_f32 v105, s72, v105
    v_mul_f32 v106, s72, v106
    v_mul_f32 v107, s72, v107
    v_cvt_pk_bf16_f32 v108, v104, v105
    v_cvt_pk_bf16_f32 v110, v132, v133
    v_mfma_f32_32x32x16_bf16 v[168:183], a[108:111], a[236:239], v[168:183]
    v_cvt_pk_bf16_f32 v109, v106, v107
    v_cvt_pk_bf16_f32 v111, v134, v135
    v_lshlrev_b32 v104, 16, v108
    v_and_b32 v105, 0xffff0000, v108
    v_lshlrev_b32 v132, 16, v110
    v_and_b32 v133, 0xffff0000, v110
    v_lshlrev_b32 v106, 16, v109
    v_and_b32 v107, 0xffff0000, v109
    v_lshlrev_b32 v134, 16, v111
    v_and_b32 v135, 0xffff0000, v111
    s_waitcnt vmcnt(16)
    v_mfma_f32_32x32x16_bf16 v[152:167], a[112:115], a[240:243], v[152:167]
    buffer_load_dwordx4 a[236:239], v73, s[56:59], s73 offen offset:3072 sc1
    v_add_f32 v132, v132, v104
    v_add_f32 v133, v133, v105
    v_add_f32 v134, v134, v106
    v_add_f32 v135, v135, v107
    v_cvt_pk_bf16_f32 v94, v132, v133
    v_cvt_pk_bf16_f32 v95, v134, v135
    v_permlane16_swap_b32 v88, v90
    v_permlane16_swap_b32 v89, v91
    v_mfma_f32_32x32x16_bf16 v[168:183], a[116:119], a[240:243], v[168:183]
    buffer_store_dwordx4 v[88:91], v86, s[56:59], 0 offen offset:0 sc1
    v_permlane16_swap_b32 v92, v94
    v_permlane16_swap_b32 v93, v95
    buffer_store_dwordx4 v[92:95], v86, s[56:59], 0 offen offset:1024 sc1
    s_waitcnt vmcnt(18)
    v_mfma_f32_32x32x16_bf16 v[152:167], a[120:123], a[244:247], v[152:167]
    buffer_load_dwordx4 a[240:243], v73, s[56:59], s74 offen offset:0 sc1
    ds_read_b128 v[96:99], v13
    ds_read_b128 v[100:103], v13 offset:1024
    v_mov_b32 v136, 0
    v_mov_b32 v137, 0
    v_mov_b32 v138, 0
    v_mov_b32 v139, 0
    v_mov_b32 v140, 0
    v_mov_b32 v141, 0
    v_mfma_f32_32x32x16_bf16 v[168:183], a[124:127], a[244:247], v[168:183]
    v_mov_b32 v142, 0
    v_mov_b32 v143, 0
    s_waitcnt lgkmcnt(0)
    v_lshlrev_b32 v104, 16, v96
    v_and_b32 v105, 0xffff0000, v96
    v_lshlrev_b32 v106, 16, v97
    v_and_b32 v107, 0xffff0000, v97
    v_lshlrev_b32 v108, 16, v98
    v_and_b32 v109, 0xffff0000, v98
    v_lshlrev_b32 v110, 16, v99
    s_waitcnt vmcnt(18)
    v_mfma_f32_32x32x16_bf16 v[152:167], a[128:131], a[248:251], v[152:167]
    buffer_load_dwordx4 a[244:247], v73, s[56:59], s74 offen offset:1024 sc1
    v_and_b32 v111, 0xffff0000, v99
    v_lshlrev_b32 v112, 16, v100
    v_and_b32 v113, 0xffff0000, v100
    v_lshlrev_b32 v114, 16, v101
    v_and_b32 v115, 0xffff0000, v101
    v_lshlrev_b32 v116, 16, v102
    v_and_b32 v117, 0xffff0000, v102
    v_lshlrev_b32 v118, 16, v103
    v_mfma_f32_32x32x16_bf16 v[168:183], a[132:135], a[248:251], v[168:183]
    v_and_b32 v119, 0xffff0000, v103
    v_sub_f32 v120, v104, v40
    v_sub_f32 v121, v105, v40
    v_cvt_pk_bf16_f32 v30, v120, v121
    v_lshlrev_b32 v120, 16, v30
    v_and_b32 v121, 0xffff0000, v30
    v_mul_f32 v120, v120, v41
    v_mul_f32 v121, v121, v41
    v_cvt_pk_bf16_f32 v30, v120, v121
    v_lshlrev_b32 v120, 16, v30
    s_waitcnt vmcnt(18)
    v_mfma_f32_32x32x16_bf16 v[152:167], a[136:139], a[252:255], v[152:167]
    buffer_load_dwordx4 a[248:251], v73, s[56:59], s74 offen offset:2048 sc1
    v_and_b32 v121, 0xffff0000, v30
    v_sub_f32 v122, v106, v40
    v_sub_f32 v123, v107, v40
    v_cvt_pk_bf16_f32 v30, v122, v123
    v_lshlrev_b32 v122, 16, v30
    v_and_b32 v123, 0xffff0000, v30
    v_mul_f32 v122, v122, v41
    v_mul_f32 v123, v123, v41
    v_mfma_f32_32x32x16_bf16 v[168:183], a[140:143], a[252:255], v[168:183]
    v_cvt_pk_bf16_f32 v30, v122, v123
    v_lshlrev_b32 v122, 16, v30
    v_and_b32 v123, 0xffff0000, v30
    v_sub_f32 v124, v108, v40
    v_sub_f32 v125, v109, v40
    v_cvt_pk_bf16_f32 v30, v124, v125
    v_lshlrev_b32 v124, 16, v30
    v_and_b32 v125, 0xffff0000, v30
    v_mul_f32 v124, v124, v41
    v_mul_f32 v125, v125, v41
    s_waitcnt vmcnt(18)
    v_mfma_f32_32x32x16_bf16 v[152:167], a[144:147], v[216:219], v[152:167]
    buffer_load_dwordx4 a[252:255], v73, s[56:59], s74 offen offset:3072 sc1
    v_cvt_pk_bf16_f32 v30, v124, v125
    v_lshlrev_b32 v124, 16, v30
    v_and_b32 v125, 0xffff0000, v30
    v_sub_f32 v126, v110, v40
    v_sub_f32 v127, v111, v40
    v_cvt_pk_bf16_f32 v30, v126, v127
    v_lshlrev_b32 v126, 16, v30
    v_and_b32 v127, 0xffff0000, v30
    v_mfma_f32_32x32x16_bf16 v[168:183], a[148:151], v[216:219], v[168:183]
    v_mul_f32 v126, v126, v41
    v_mul_f32 v127, v127, v41
    v_cvt_pk_bf16_f32 v30, v126, v127
    v_lshlrev_b32 v126, 16, v30
    v_and_b32 v127, 0xffff0000, v30
    v_sub_f32 v128, v112, v42
    v_sub_f32 v129, v113, v42
    v_cvt_pk_bf16_f32 v30, v128, v129
    v_lshlrev_b32 v128, 16, v30
    v_and_b32 v129, 0xffff0000, v30
    s_waitcnt vmcnt(18)
    v_mfma_f32_32x32x16_bf16 v[152:167], a[152:155], v[220:223], v[152:167]
    buffer_load_dwordx4 v[216:219], v73, s[56:59], s75 offen offset:0 sc1
    v_mul_f32 v128, v128, v43
    v_mul_f32 v129, v129, v43
    v_cvt_pk_bf16_f32 v30, v128, v129
    v_lshlrev_b32 v128, 16, v30
    v_and_b32 v129, 0xffff0000, v30
    v_sub_f32 v130, v114, v42
    v_sub_f32 v131, v115, v42
    v_cvt_pk_bf16_f32 v30, v130, v131
    v_mfma_f32_32x32x16_bf16 v[168:183], a[156:159], v[220:223], v[168:183]
    v_lshlrev_b32 v130, 16, v30
    v_and_b32 v131, 0xffff0000, v30
    v_mul_f32 v130, v130, v43
    v_mul_f32 v131, v131, v43
    v_cvt_pk_bf16_f32 v30, v130, v131
    v_lshlrev_b32 v130, 16, v30
    v_and_b32 v131, 0xffff0000, v30
    v_sub_f32 v132, v116, v42
    v_sub_f32 v133, v117, v42
    v_cvt_pk_bf16_f32 v30, v132, v133
    s_waitcnt vmcnt(18)
    v_mfma_f32_32x32x16_bf16 v[152:167], a[160:163], v[224:227], v[152:167]
    buffer_load_dwordx4 v[220:223], v73, s[56:59], s75 offen offset:1024 sc1
    v_lshlrev_b32 v132, 16, v30
    v_and_b32 v133, 0xffff0000, v30
    v_mul_f32 v132, v132, v43
    v_mul_f32 v133, v133, v43
    v_cvt_pk_bf16_f32 v30, v132, v133
    v_lshlrev_b32 v132, 16, v30
    v_and_b32 v133, 0xffff0000, v30
    v_sub_f32 v134, v118, v42
    v_mfma_f32_32x32x16_bf16 v[168:183], a[164:167], v[224:227], v[168:183]
    v_sub_f32 v135, v119, v42
    v_cvt_pk_bf16_f32 v30, v134, v135
    v_lshlrev_b32 v134, 16, v30
    v_and_b32 v135, 0xffff0000, v30
    v_mul_f32 v134, v134, v43
    v_mul_f32 v135, v135, v43
    v_cvt_pk_bf16_f32 v30, v134, v135
    v_lshlrev_b32 v134, 16, v30
    v_and_b32 v135, 0xffff0000, v30
    s_waitcnt vmcnt(18)
    v_mfma_f32_32x32x16_bf16 v[152:167], a[168:171], v[228:231], v[152:167]
    buffer_load_dwordx4 v[224:227], v73, s[56:59], s75 offen offset:2048 sc1
    v_mfma_f32_32x32x16_bf16 v[168:183], a[172:175], v[228:231], v[168:183]
    s_waitcnt vmcnt(18)
    v_mfma_f32_32x32x16_bf16 v[152:167], a[176:179], v[232:235], v[152:167]
    buffer_load_dwordx4 v[228:231], v73, s[56:59], s75 offen offset:3072 sc1
    s_waitcnt vmcnt(8)
    s_mov_b64 exec, 1
    buffer_store_dword v22, v23, s[56:59], 0 offen offset:32 sc1
    s_mov_b64 exec, -1
    v_mfma_f32_32x32x16_bf16 v[168:183], a[180:183], v[232:235], v[168:183]
    v_mfma_f32_32x32x16_bf16 v[152:167], a[184:187], v[236:239], v[152:167]
    buffer_load_dwordx4 v[232:235], v73, s[56:59], s76 offen offset:0 sc1
    v_mfma_f32_32x32x16_bf16 v[168:183], a[188:191], v[236:239], v[168:183]
    v_mfma_f32_32x32x16_bf16 v[152:167], a[192:195], v[240:243], v[152:167]
    buffer_load_dwordx4 v[236:239], v73, s[56:59], s76 offen offset:1024 sc1
    v_mfma_f32_32x32x16_bf16 v[168:183], a[196:199], v[240:243], v[168:183]
    v_mfma_f32_32x32x16_bf16 v[152:167], a[200:203], v[244:247], v[152:167]
    buffer_load_dwordx4 v[240:243], v73, s[56:59], s76 offen offset:2048 sc1
    v_mfma_f32_32x32x16_bf16 v[168:183], a[204:207], v[244:247], v[168:183]
    v_mfma_f32_32x32x16_bf16 v[152:167], a[208:211], v[248:251], v[152:167]
    buffer_load_dwordx4 v[244:247], v73, s[56:59], s76 offen offset:3072 sc1
    v_mfma_f32_32x32x16_bf16 v[168:183], a[212:215], v[248:251], v[168:183]
    v_mfma_f32_32x32x16_bf16 v[152:167], a[216:219], v[252:255], v[152:167]
    buffer_load_dwordx4 v[248:251], v73, s[56:59], s77 offen offset:0 sc1
    v_mfma_f32_32x32x16_bf16 v[168:183], a[220:223], v[252:255], v[168:183]
    v_mfma_f32_32x32x16_bf16 v[184:199], a[0:3], a[224:227], 0
    buffer_load_dwordx4 v[252:255], v73, s[56:59], s77 offen offset:1024 sc1
    v_mfma_f32_32x32x16_bf16 v[200:215], a[4:7], a[224:227], 0
    s_nop 6
    ds_write_b128 v2, v[152:155] offset:0
    v_mfma_f32_32x32x16_bf16 v[184:199], a[8:11], a[228:231], v[184:199]
    buffer_load_dwordx4 a[224:227], v73, s[56:59], s77 offen offset:2048 sc1
    v_mfma_f32_32x32x16_bf16 v[200:215], a[12:15], a[228:231], v[200:215]
    ds_write_b128 v3, v[156:159] offset:0
    v_mfma_f32_32x32x16_bf16 v[184:199], a[16:19], a[232:235], v[184:199]
    buffer_load_dwordx4 a[228:231], v73, s[56:59], s77 offen offset:3072 sc1
    ds_write_b128 v4, v[160:163] offset:0
    v_mfma_f32_32x32x16_bf16 v[200:215], a[20:23], a[232:235], v[200:215]
    ds_write_b128 v5, v[164:167] offset:0
    v_mfma_f32_32x32x16_bf16 v[184:199], a[24:27], a[236:239], v[184:199]
    buffer_load_dwordx4 a[232:235], v73, s[56:59], s78 offen offset:0 sc1
    ds_write_b128 v2, v[168:171] offset:128
    v_mfma_f32_32x32x16_bf16 v[200:215], a[28:31], a[236:239], v[200:215]
    ds_write_b128 v3, v[172:175] offset:128
    s_waitcnt vmcnt(17)
    v_mfma_f32_32x32x16_bf16 v[184:199], a[32:35], a[240:243], v[184:199]
    buffer_load_dwordx4 a[236:239], v73, s[56:59], s78 offen offset:1024 sc1
    ds_write_b128 v4, v[176:179] offset:128
    v_mfma_f32_32x32x16_bf16 v[200:215], a[36:39], a[240:243], v[200:215]
    ds_write_b128 v5, v[180:183] offset:128
    s_waitcnt vmcnt(17)
    v_mfma_f32_32x32x16_bf16 v[184:199], a[40:43], a[244:247], v[184:199]
    buffer_load_dwordx4 a[240:243], v73, s[56:59], s78 offen offset:2048 sc1
    v_mfma_f32_32x32x16_bf16 v[200:215], a[44:47], a[244:247], v[200:215]
    s_waitcnt lgkmcnt(0)
    s_barrier
    s_waitcnt vmcnt(17)
    v_mfma_f32_32x32x16_bf16 v[184:199], a[48:51], a[248:251], v[184:199]
    buffer_load_dwordx4 a[244:247], v73, s[56:59], s78 offen offset:3072 sc1
    ds_read_b128 v[88:91], v6 offset:0
    ds_read_b128 v[92:95], v6 offset:8192
    ds_read_b128 v[96:99], v6 offset:16384
    v_mfma_f32_32x32x16_bf16 v[200:215], a[52:55], a[248:251], v[200:215]
    ds_read_b128 v[100:103], v6 offset:24576
    ds_read_b128 v[44:47], v7 offset:0
    ds_read_b128 v[48:51], v7 offset:8192
    ds_read_b128 v[52:55], v7 offset:16384
    ds_read_b128 v[56:59], v7 offset:24576
    s_waitcnt vmcnt(17)
    v_mfma_f32_32x32x16_bf16 v[184:199], a[56:59], a[252:255], v[184:199]
    buffer_load_dwordx4 a[248:251], v73, s[56:59], s79 offen offset:0 sc1
    v_mfma_f32_32x32x16_bf16 v[200:215], a[60:63], a[252:255], v[200:215]
    s_waitcnt vmcnt(17)
    v_mfma_f32_32x32x16_bf16 v[184:199], a[64:67], v[216:219], v[184:199]
    buffer_load_dwordx4 a[252:255], v73, s[56:59], s79 offen offset:1024 sc1
    v_mfma_f32_32x32x16_bf16 v[200:215], a[68:71], v[216:219], v[200:215]
    s_waitcnt lgkmcnt(4)
    v_add_f32 v88, v88, v92
    v_add_f32 v96, v96, v100
    v_add_f32 v89, v89, v93
    v_add_f32 v97, v97, v101
    s_waitcnt vmcnt(17)
    v_mfma_f32_32x32x16_bf16 v[184:199], a[72:75], v[220:223], v[184:199]
    buffer_load_dwordx4 v[216:219], v73, s[56:59], s79 offen offset:2048 sc1
    v_add_f32 v90, v90, v94
    v_add_f32 v98, v98, v102
    v_add_f32 v91, v91, v95
    v_mfma_f32_32x32x16_bf16 v[200:215], a[76:79], v[220:223], v[200:215]
    v_add_f32 v99, v99, v103
    v_add_f32 v88, v88, v96
    v_add_f32 v89, v89, v97
    v_add_f32 v90, v90, v98
    v_add_f32 v91, v91, v99
    s_waitcnt vmcnt(17)
    v_mfma_f32_32x32x16_bf16 v[184:199], a[80:83], v[224:227], v[184:199]
    buffer_load_dwordx4 v[220:223], v73, s[56:59], s79 offen offset:3072 sc1
    v_mul_f32 v88, v88, v60
    v_mul_f32 v89, v89, v60
    v_mul_f32 v90, v90, v60
    v_mfma_f32_32x32x16_bf16 v[200:215], a[84:87], v[224:227], v[200:215]
    v_mul_f32 v91, v91, v60
    v_exp_f32 v92, v88
    v_exp_f32 v93, v89
    s_waitcnt vmcnt(17)
    v_mfma_f32_32x32x16_bf16 v[184:199], a[88:91], v[228:231], v[184:199]
    v_exp_f32 v94, v90
    v_exp_f32 v95, v91
    v_fma_f32 v92, v92, v60, v60
    v_mfma_f32_32x32x16_bf16 v[200:215], a[92:95], v[228:231], v[200:215]
    v_fma_f32 v93, v93, v60, v60
    v_fma_f32 v94, v94, v60, v60
    v_fma_f32 v95, v95, v60, v60
    v_rcp_f32 v92, v92
    s_waitcnt vmcnt(15)
    v_mfma_f32_32x32x16_bf16 v[184:199], a[96:99], v[232:235], v[184:199]
    v_rcp_f32 v93, v93
    v_rcp_f32 v94, v94
    v_rcp_f32 v95, v95
    v_mfma_f32_32x32x16_bf16 v[200:215], a[100:103], v[232:235], v[200:215]
    v_mul_f32 v120, v88, v120
    v_mul_f32 v121, v89, v121
    v_mul_f32 v122, v90, v122
    v_mul_f32 v123, v91, v123
    v_mul_f32 v120, v92, v120
    s_waitcnt vmcnt(14)
    v_mfma_f32_32x32x16_bf16 v[184:199], a[104:107], v[236:239], v[184:199]
    v_mul_f32 v121, v93, v121
    v_mul_f32 v122, v94, v122
    v_mul_f32 v123, v95, v123
    s_waitcnt lgkmcnt(0)
    v_add_f32 v44, v44, v48
    v_mfma_f32_32x32x16_bf16 v[200:215], a[108:111], v[236:239], v[200:215]
    v_add_f32 v52, v52, v56
    v_add_f32 v45, v45, v49
    v_add_f32 v53, v53, v57
    v_add_f32 v46, v46, v50
    v_add_f32 v54, v54, v58
    s_waitcnt vmcnt(13)
    v_mfma_f32_32x32x16_bf16 v[184:199], a[112:115], v[240:243], v[184:199]
    v_add_f32 v47, v47, v51
    v_add_f32 v55, v55, v59
    v_add_f32 v44, v44, v52
    v_add_f32 v45, v45, v53
    v_add_f32 v46, v46, v54
    v_mfma_f32_32x32x16_bf16 v[200:215], a[116:119], v[240:243], v[200:215]
    v_add_f32 v47, v47, v55
    v_mul_f32 v44, v44, v60
    v_mul_f32 v45, v45, v60
    v_mul_f32 v46, v46, v60
    v_mul_f32 v47, v47, v60
    s_waitcnt vmcnt(12)
    v_mfma_f32_32x32x16_bf16 v[184:199], a[120:123], v[244:247], v[184:199]
    v_exp_f32 v48, v44
    v_exp_f32 v49, v45
    v_exp_f32 v50, v46
    v_mfma_f32_32x32x16_bf16 v[200:215], a[124:127], v[244:247], v[200:215]
    v_exp_f32 v51, v47
    v_fma_f32 v48, v48, v60, v60
    v_fma_f32 v49, v49, v60, v60
    v_fma_f32 v50, v50, v60, v60
    buffer_load_dword v25, v75, s[56:59], 0 offen sc1
    s_waitcnt vmcnt(12)
    v_mfma_f32_32x32x16_bf16 v[184:199], a[128:131], v[248:251], v[184:199]
    v_fma_f32 v51, v51, v60, v60
    v_rcp_f32 v48, v48
    v_rcp_f32 v49, v49
    v_mfma_f32_32x32x16_bf16 v[200:215], a[132:135], v[248:251], v[200:215]
    v_rcp_f32 v50, v50
    v_rcp_f32 v51, v51
    v_mul_f32 v124, v44, v124
    s_waitcnt vmcnt(11)
    v_mfma_f32_32x32x16_bf16 v[184:199], a[136:139], v[252:255], v[184:199]
    v_mul_f32 v125, v45, v125
    v_mul_f32 v126, v46, v126
    v_mul_f32 v127, v47, v127
    v_mul_f32 v124, v48, v124
    v_mul_f32 v125, v49, v125
    v_mfma_f32_32x32x16_bf16 v[200:215], a[140:143], v[252:255], v[200:215]
    v_mul_f32 v126, v50, v126
    v_mul_f32 v127, v51, v127
    s_waitcnt vmcnt(10)
    v_mfma_f32_32x32x16_bf16 v[184:199], a[144:147], a[224:227], v[184:199]
    v_mfma_f32_32x32x16_bf16 v[200:215], a[148:151], a[224:227], v[200:215]
    s_waitcnt vmcnt(9)
    v_mfma_f32_32x32x16_bf16 v[184:199], a[152:155], a[228:231], v[184:199]
    v_mfma_f32_32x32x16_bf16 v[200:215], a[156:159], a[228:231], v[200:215]
    s_waitcnt vmcnt(8)
    v_mfma_f32_32x32x16_bf16 v[184:199], a[160:163], a[232:235], v[184:199]
    v_mfma_f32_32x32x16_bf16 v[200:215], a[164:167], a[232:235], v[200:215]
    s_waitcnt vmcnt(7)
    v_mfma_f32_32x32x16_bf16 v[184:199], a[168:171], a[236:239], v[184:199]
    v_mfma_f32_32x32x16_bf16 v[200:215], a[172:175], a[236:239], v[200:215]
    s_waitcnt vmcnt(0)
    v_cmp_ne_u32 vcc, s60, v25
    s_nop 4
    s_cbranch_vccz L_ok_19
    s_mov_b32 s96, 200000
L_spin_20:
    s_sleep 2
    buffer_load_dword v25, v75, s[56:59], 0 offen sc1
    s_waitcnt vmcnt(0)
    s_sub_u32 s96, s96, 1
    s_cbranch_scc1 L_ok_19
    v_cmp_ne_u32 vcc, s60, v25
    s_nop 4
    s_cbranch_vccnz L_spin_20
L_ok_19:
    s_mov_b32 m0, s12
    s_nop 0
    buffer_load_dwordx4 v82, s[56:59], s9 offen sc1 lds
    s_add_u32 s9, s9, 31728
    buffer_load_dwordx4 v82, s[56:59], s9 offen offset:1040 sc1 lds
    s_cmp_lg_u32 s2, 0
    s_cbranch_scc1 L_noep_21
    s_lshl_b32 s64, s61, 13
    s_add_u32 s64, s64, 4144
    v_lshl_add_u32 v36, v1, 7, s64
    buffer_load_dword v37, v36, s[56:59], 0 offen sc1
    s_waitcnt vmcnt(0)
    v_cmp_ne_u32 vcc, s60, v37
    s_nop 4
    s_cbranch_vccz L_ok_22
    s_mov_b32 s96, 200000
L_spin_23:
    s_sleep 2
    buffer_load_dword v37, v36, s[56:59], 0 offen sc1
    s_waitcnt vmcnt(0)
    s_sub_u32 s96, s96, 1
    s_cbranch_scc1 L_ok_22
    v_cmp_ne_u32 vcc, s60, v37
    s_nop 4
    s_cbranch_vccnz L_spin_23
L_ok_22:
L_noep_21:
    v_mfma_f32_32x32x16_bf16 v[184:199], a[176:179], a[240:243], v[184:199]
    v_mfma_f32_32x32x16_bf16 v[200:215], a[180:183], a[240:243], v[200:215]
    v_mfma_f32_32x32x16_bf16 v[184:199], a[184:187], a[244:247], v[184:199]
    v_mfma_f32_32x32x16_bf16 v[200:215], a[188:191], a[244:247], v[200:215]
    v_mfma_f32_32x32x16_bf16 v[184:199], a[192:195], a[248:251], v[184:199]
    v_mfma_f32_32x32x16_bf16 v[200:215], a[196:199], a[248:251], v[200:215]
    v_mfma_f32_32x32x16_bf16 v[184:199], a[200:203], a[252:255], v[184:199]
    v_mfma_f32_32x32x16_bf16 v[200:215], a[204:207], a[252:255], v[200:215]
    v_mfma_f32_32x32x16_bf16 v[184:199], a[208:211], v[216:219], v[184:199]
    v_mfma_f32_32x32x16_bf16 v[200:215], a[212:215], v[216:219], v[200:215]
    v_mfma_f32_32x32x16_bf16 v[184:199], a[216:219], v[220:223], v[184:199]
    v_mfma_f32_32x32x16_bf16 v[200:215], a[220:223], v[220:223], v[200:215]
    s_nop 10
    ds_write_b128 v2, v[184:187] offset:32768
    ds_write_b128 v3, v[188:191] offset:32768
    ds_write_b128 v4, v[192:195] offset:32768
    ds_write_b128 v5, v[196:199] offset:32768
    ds_write_b128 v2, v[200:203] offset:32896
    ds_write_b128 v3, v[204:207] offset:32896
    ds_write_b128 v4, v[208:211] offset:32896
    ds_write_b128 v5, v[212:215] offset:32896
    s_waitcnt vmcnt(0) lgkmcnt(0)
    s_barrier
    v_mov_b64 v[152:153], 0
    v_mov_b64 v[154:155], 0
    v_mov_b64 v[156:157], 0
    v_mov_b64 v[158:159], 0
    ds_read_u16_d16_hi v136, v12 offset:0
    ds_read_u16_d16_hi v137, v12 offset:128
    ds_read_u16_d16_hi v138, v12 offset:256
    ds_read_u16_d16_hi v139, v12 offset:384
    ds_read_u16_d16_hi v140, v12 offset:512
    ds_read_u16_d16_hi v141, v12 offset:640
    ds_read_u16_d16_hi v142, v12 offset:768
    ds_read_u16_d16_hi v143, v12 offset:896
    ds_read_b128 v[88:91], v6 offset:32768
    ds_read_b128 v[92:95], v6 offset:40960
    ds_read_b128 v[96:99], v6 offset:49152
    ds_read_b128 v[100:103], v6 offset:57344
    ds_read_b128 v[44:47], v7 offset:32768
    ds_read_b128 v[48:51], v7 offset:40960
    ds_read_b128 v[52:55], v7 offset:49152
    ds_read_b128 v[56:59], v7 offset:57344
    ds_read_u16_d16_hi v152, v12 offset:32
    ds_read_u16_d16_hi v153, v12 offset:160
    ds_read_u16_d16_hi v154, v12 offset:288
    ds_read_u16_d16_hi v155, v12 offset:416
    ds_read_u16_d16_hi v156, v12 offset:544
    ds_read_u16_d16_hi v157, v12 offset:672
    ds_read_u16_d16_hi v158, v12 offset:800
    ds_read_u16_d16_hi v159, v12 offset:928
    s_cmp_lg_u32 s2, 0
    s_cbranch_scc1 L_noes_24
    v_mov_b32 v36, 0
    s_mov_b64 exec, 1
    buffer_store_dword v22, v36, s[56:59], 0 offen sc1
    s_mov_b64 exec, -1
L_noes_24:
    s_waitcnt lgkmcnt(15)
    v_pk_fma_f32 v[120:121], v[120:121], v[136:137], v[104:105]
    v_pk_fma_f32 v[122:123], v[122:123], v[138:139], v[106:107]
    v_pk_fma_f32 v[124:125], v[124:125], v[140:141], v[108:109]
    v_pk_fma_f32 v[126:127], v[126:127], v[142:143], v[110:111]
    v_cvt_pk_bf16_f32 v144, v120, v121
    v_cvt_pk_bf16_f32 v145, v122, v123
    v_cvt_pk_bf16_f32 v146, v124, v125
    v_cvt_pk_bf16_f32 v147, v126, v127
    buffer_store_dwordx4 v[144:147], v87, s[52:55], 0 offen sc1
    s_waitcnt lgkmcnt(12)
    v_pk_add_f32 v[88:89], v[88:89], v[92:93]
    v_pk_add_f32 v[96:97], v[96:97], v[100:101]
    v_pk_add_f32 v[90:91], v[90:91], v[94:95]
    v_pk_add_f32 v[98:99], v[98:99], v[102:103]
    v_pk_add_f32 v[88:89], v[88:89], v[96:97]
    v_pk_add_f32 v[90:91], v[90:91], v[98:99]
    v_pk_mul_f32 v[88:89], v[88:89], v[60:61] op_sel_hi:[1,0]
    v_pk_mul_f32 v[90:91], v[90:91], v[60:61] op_sel_hi:[1,0]
    v_exp_f32 v92, v88
    v_exp_f32 v93, v89
    v_exp_f32 v94, v90
    v_exp_f32 v95, v91
    s_waitcnt lgkmcnt(0)
    v_pk_mul_f32 v[128:129], v[128:129], v[152:153]
    v_pk_mul_f32 v[130:131], v[130:131], v[154:155]
    v_pk_mul_f32 v[132:133], v[132:133], v[156:157]
    v_pk_mul_f32 v[134:135], v[134:135], v[158:159]
    v_pk_fma_f32 v[92:93], v[92:93], v[60:61], v[60:61] op_sel_hi:[1,0,0]
    v_pk_fma_f32 v[94:95], v[94:95], v[60:61], v[60:61] op_sel_hi:[1,0,0]
    v_rcp_f32 v92, v92
    v_rcp_f32 v93, v93
    v_rcp_f32 v94, v94
    v_rcp_f32 v95, v95
    v_pk_mul_f32 v[88:89], v[88:89], v[128:129]
    v_pk_mul_f32 v[90:91], v[90:91], v[130:131]
    v_pk_fma_f32 v[88:89], v[88:89], v[92:93], v[112:113]
    v_pk_fma_f32 v[90:91], v[90:91], v[94:95], v[114:115]
    v_cvt_pk_bf16_f32 v148, v88, v89
    v_cvt_pk_bf16_f32 v149, v90, v91
    v_pk_add_f32 v[44:45], v[44:45], v[48:49]
    v_pk_add_f32 v[52:53], v[52:53], v[56:57]
    v_pk_add_f32 v[46:47], v[46:47], v[50:51]
    v_pk_add_f32 v[54:55], v[54:55], v[58:59]
    v_pk_add_f32 v[44:45], v[44:45], v[52:53]
    v_pk_add_f32 v[46:47], v[46:47], v[54:55]
    v_pk_mul_f32 v[44:45], v[44:45], v[60:61] op_sel_hi:[1,0]
    v_pk_mul_f32 v[46:47], v[46:47], v[60:61] op_sel_hi:[1,0]
    v_exp_f32 v48, v44
    v_exp_f32 v49, v45
    v_exp_f32 v50, v46
    v_exp_f32 v51, v47
    v_pk_fma_f32 v[48:49], v[48:49], v[60:61], v[60:61] op_sel_hi:[1,0,0]
    v_pk_fma_f32 v[50:51], v[50:51], v[60:61], v[60:61] op_sel_hi:[1,0,0]
    v_rcp_f32 v48, v48
    v_rcp_f32 v49, v49
    v_rcp_f32 v50, v50
    v_rcp_f32 v51, v51
    v_pk_mul_f32 v[44:45], v[44:45], v[132:133]
    v_pk_mul_f32 v[46:47], v[46:47], v[134:135]
    v_pk_fma_f32 v[44:45], v[44:45], v[48:49], v[116:117]
    v_pk_fma_f32 v[46:47], v[46:47], v[50:51], v[118:119]
    v_cvt_pk_bf16_f32 v150, v44, v45
    v_cvt_pk_bf16_f32 v151, v46, v47
    buffer_store_dwordx4 v[148:151], v87, s[52:55], s16 offen sc1
L_tail:
    s_endpgm
L_spare:
    s_mov_b32 s40, s12
    s_and_b32 s41, s13, 0xffff
    s_mov_b32 s42, 2097152
    s_mov_b32 s43, 0x20000
    s_lshl_b32 s64, s2, 13
    s_lshl_b32 s65, s61, 11
    s_add_u32 s64, s64, s65
    v_lshl_add_u32 v44, v1, 4, s64
    v_subrev_u32 v27, 8, v44
    v_and_b32 v28, 4095, v44
    v_mov_b32 v29, 0x7fffffff
    v_cmp_eq_u32 vcc, 0, v28
    s_nop 1
    v_cndmask_b32 v45, v27, v29, vcc
    buffer_load_dwordx4 v[46:49], v44, s[40:43], 0 offen nt
    buffer_load_dwordx4 v[52:55], v44, s[40:43], 0 offen offset:1024 nt
    buffer_load_dwordx2 v[50:51], v44, s[40:43], 0 offen offset:1016 nt
    buffer_load_dwordx2 v[44:45], v45, s[40:43], 0 offen nt
    s_mov_b32 s52, s22
    s_and_b32 s53, s23, 0xffff
    s_mov_b32 s54, 2097152
    s_mov_b32 s55, 0x20000
    s_mov_b32 s56, s26
    s_and_b32 s57, s27, 0xffff
    s_mov_b32 s58, 67108864
    s_mov_b32 s59, 0x20000
    s_mov_b32 s48, s20
    s_and_b32 s49, s21, 0xffff
    s_mov_b32 s50, 1835008
    s_mov_b32 s51, 0x20000
    s_lshr_b32 s67, s62, 1
    s_lshl_b32 s67, s67, 3
    s_and_b32 s64, s63, 7
    s_add_u32 s67, s67, s64
    s_and_b32 s66, s62, 1
    s_lshl_b32 s66, s66, 2
    s_lshr_b32 s65, s63, 3
    s_add_u32 s66, s66, s65
    s_lshr_b32 s17, s61, 1
    s_and_b32 s18, s61, 1
    s_mov_b32 s13, 114688
    s_mov_b32 s16, 32768
    s_waitcnt lgkmcnt(0)
    s_mul_i32 s60, s60, 0x9E3779B1
    s_add_u32 s60, s60, 0x7F4A7C15
    v_mov_b32 v22, s60
    s_lshl_b32 s64, s2, 7
    s_lshl_b32 s65, s61, 2
    s_add_u32 s64, s64, s65
    s_add_u32 s64, s64, 4096
    v_mov_b32 v23, s64
    s_mul_i32 s64, s61, 5120
    s_add_u32 s64, s64, 131712
    v_lshlrev_b32 v40, 10, v32
    v_lshl_add_u32 v40, v33, 2, v40
    v_add_u32 v40, s64, v40
    v_add_u32 v41, 1024, v40
    v_add_u32 v42, 2432, v40
    s_lshl_b32 s64, s61, 1
    v_add_u32 v43, s64, v32
    v_and_b32 v18, 7, v33
    v_xor_b32 v43, v43, v18
    v_lshlrev_b32 v43, 4, v43
    v_lshl_add_u32 v43, v33, 8, v43
    v_add_u32 v43, 151552, v43
    v_lshrrev_b32 v18, 4, v1
    v_xor_b32 v18, v18, v35
    v_lshlrev_b32 v18, 4, v18
    v_lshl_add_u32 v18, v34, 7, v18
    s_lshl_b32 s64, s61, 11
    s_add_u32 s64, s64, 151552
    v_add_u32 v18, s64, v18
    v_xor_b32 v19, 64, v18
    v_lshlrev_b32 v63, 12, v34
    v_lshl_add_u32 v63, v35, 4, v63
    s_lshl_b32 s64, s62, 18
    s_lshl_b32 s65, s61, 16
    s_add_u32 s64, s64, s65
    s_lshl_b32 s65, s63, 7
    s_add_u32 s64, s64, s65
    s_add_u32 s64, s64, 1048576
    v_add_u32 v63, s64, v63
    s_mul_i32 s64, s17, 4608
    s_lshl_b32 s65, s18, 8
    s_add_u32 s64, s64, s65
    s_add_u32 s64, s64, 131584
    v_lshl_add_u32 v67, v1, 2, s64
    s_mov_b32 s64, 0
    s_lshl_b32 s73, s64, 12
    s_add_u32 s64, s64, 1
    s_cmp_ge_u32 s64, 7
    s_cselect_b32 s64, 0, s64
    s_lshl_b32 s74, s64, 12
    s_add_u32 s64, s64, 1
    s_cmp_ge_u32 s64, 7
    s_cselect_b32 s64, 0, s64
    s_lshl_b32 s75, s64, 12
    s_add_u32 s64, s64, 1
    s_cmp_ge_u32 s64, 7
    s_cselect_b32 s64, 0, s64
    s_lshl_b32 s76, s64, 12
    s_add_u32 s64, s64, 1
    s_cmp_ge_u32 s64, 7
    s_cselect_b32 s64, 0, s64
    s_lshl_b32 s77, s64, 12
    s_add_u32 s64, s64, 1
    s_cmp_ge_u32 s64, 7
    s_cselect_b32 s64, 0, s64
    s_lshl_b32 s78, s64, 12
    s_add_u32 s64, s64, 1
    s_cmp_ge_u32 s64, 7
    s_cselect_b32 s64, 0, s64
    s_lshl_b32 s79, s64, 12
    v_and_b32 v27, 16, v1
    v_lshrrev_b32 v27, 2, v27
    v_xor_b32 v27, v27, v35
    v_lshlrev_b32 v26, 10, v34
    v_lshl_add_u32 v26, v27, 4, v26
    s_mul_i32 s64, s61, 458752
    s_lshl_b32 s65, s66, 7
    s_add_u32 s64, s64, s65
    v_add_u32 v16, s64, v26
    v_add_u32 v17, 7168, v16
    v_add_u32 v20, 14336, v16
    v_add_u32 v24, 21504, v16
    v_lshlrev_b32 v26, 2, v32
    v_bfe_u32 v27, v1, 2, 2
    v_add_u32 v26, v26, v27
    v_lshlrev_b32 v26, 7, v26
    v_bfe_u32 v27, v1, 4, 1
    v_lshlrev_b32 v27, 1, v27
    v_bfe_u32 v28, v1, 1, 1
    v_or_b32 v27, v27, v28
    v_bfe_u32 v28, v1, 3, 1
    v_lshl_or_b32 v27, v28, 2, v27
    v_lshl_add_u32 v26, v27, 4, v26
    v_and_b32 v27, 1, v1
    v_lshl_add_u32 v26, v27, 3, v26
    s_lshl_b32 s19, s61, 13
    v_add_u32 v21, s19, v26
    v_xor_b32 v0, 64, v21
    v_lshrrev_b32 v26, 2, v1
    v_min_u32 v27, 6, v26
    s_mul_i32 s64, s61, 7
    v_add_u32 v27, s64, v27
    v_and_b32 v28, 1, v27
    v_lshrrev_b32 v27, 1, v27
    v_cmp_le_u32 vcc, 7, v27
    s_nop 1
    v_cndmask_b32 v29, 0, 1, vcc
    v_mul_u32_u24 v30, 7, v29
    v_sub_u32 v27, v27, v30
    v_lshl_add_u32 v27, v27, 5, v29
    s_lshr_b32 s64, s67, 1
    s_and_b32 s65, s64, 3
    s_lshl_b32 s65, s65, 3
    s_lshr_b32 s64, s64, 2
    s_lshl_b32 s64, s64, 1
    s_add_u32 s64, s64, s65
    v_add_u32 v27, s64, v27
    v_lshlrev_b32 v27, 7, v27
    v_lshl_add_u32 v74, v28, 2, v27
    s_and_b32 s64, s67, 1
    s_lshl_b32 s64, s64, 3
    s_add_u32 s64, s64, 4112
    v_add_u32 v74, s64, v74
    v_lshrrev_b32 v27, 1, v26
    v_and_b32 v28, 1, v26
    s_lshl_b32 s64, s66, 5
    s_lshl_b32 s65, s61, 3
    s_add_u32 s64, s64, s65
    v_add_u32 v27, s64, v27
    v_lshlrev_b32 v27, 7, v27
    v_lshl_add_u32 v75, v28, 3, v27
    s_lshr_b32 s64, s67, 4
    s_lshl_b32 s64, s64, 2
    s_add_u32 s64, s64, 4128
    v_add_u32 v75, s64, v75
    s_lshr_b32 s64, s2, 5
    s_lshl_b32 s65, s18, 7
    s_add_u32 s64, s64, s65
    v_lshl_add_u32 v36, v26, 3, s64
    v_lshlrev_b32 v36, 7, v36
    s_and_b32 s64, s63, 3
    s_lshl_b32 s64, s64, 2
    s_add_u32 s64, s64, 4144
    v_add_u32 v36, s64, v36
    s_lshl_b32 s64, s2, 13
    s_lshl_b32 s65, s61, 11
    s_add_u32 s64, s64, s65
    s_add_u32 s64, s64, 1048576
    v_lshl_add_u32 v78, v1, 4, s64
    v_and_b32 v29, 15, v1
    v_lshlrev_b32 v86, 4, v29
    v_bfe_u32 v27, v1, 4, 1
    v_lshl_add_u32 v86, v27, 9, v86
    v_lshl_add_u32 v86, v32, 8, v86
    s_add_u32 s64, s64, 3145728
    v_add_u32 v86, s64, v86
    s_mul_i32 s4, s17, 4608
    s_lshl_b32 s65, s18, 11
    s_add_u32 s4, s4, s65
    s_add_u32 s4, s4, 132096
    s_lshl_b32 s64, s67, 10
    s_lshl_b32 s65, s61, 7
    s_add_u32 s64, s64, s65
    s_add_u32 s64, s64, 65536
    v_lshl_add_u32 v80, v34, 3, s64
    v_and_b32 v27, 1, v1
    v_lshl_add_u32 v80, v27, 9, v80
    s_lshl_b32 s7, s67, 16
    s_lshl_b32 s65, s61, 13
    s_add_u32 s7, s7, s65
    s_lshl_b32 s65, s66, 7
    s_add_u32 s7, s7, s65
    s_lshl_b32 s8, s61, 13
    s_add_u32 s8, s8, 32768
    v_lshlrev_b32 v82, 12, v34
    v_and_b32 v27, 3, v1
    v_lshl_add_u32 v82, v27, 4, v82
    v_bfe_u32 v27, v1, 2, 1
    v_lshl_add_u32 v82, v27, 8, v82
    s_lshr_b32 s64, s67, 2
    s_and_b32 s12, s67, 3
    s_lshl_b32 s9, s66, 18
    s_lshl_b32 s65, s61, 16
    s_add_u32 s9, s9, s65
    s_lshl_b32 s65, s64, 9
    s_add_u32 s9, s9, s65
    s_lshl_b32 s65, s12, 6
    s_add_u32 s9, s9, s65
    s_add_u32 s9, s9, 4194304
    s_mul_i32 s12, s61, 2080
    s_add_u32 s12, s12, 106496
    s_lshl_b32 s64, s67, 16
    s_lshl_b32 s65, s61, 13
    s_add_u32 s64, s64, s65
    s_lshl_b32 s65, s66, 7
    s_add_u32 s64, s64, s65
    v_add_u32 v87, s64, v81
    s_mul_i32 s64, s67, 229376
    s_mul_i32 s65, s61, 28672
    s_add_u32 s64, s64, s65
    s_add_u32 s64, s64, 8388608
    v_lshl_add_u32 v72, v1, 4, s64
    v_add_u32 v73, 114688, v72
    s_lshl_b32 s64, s61, 12
    s_add_u32 s64, s64, 140800
    v_lshl_add_u32 v84, v1, 4, s64
    v_xor_b32 v85, 4096, v84
    s_mul_i32 s64, s17, 16640
    s_add_u32 s64, s64, 98304
    v_lshrrev_b32 v27, 1, v1
    v_mul_u32_u24 v27, 4160, v27
    v_and_b32 v28, 1, v1
    v_lshl_add_u32 v27, v28, 4, v27
    v_add_u32 v66, s64, v27
    s_lshl_b32 s65, s18, 11
    s_add_u32 s65, s65, s64
    s_add_u32 s65, s65, 32
    v_lshl_add_u32 v83, v1, 4, s65
    v_lshrrev_b32 v26, 4, v1
    v_sub_u32 v28, 3, v29
    v_and_b32 v28, 3, v28
    v_add3_u32 v27, v29, v28, 9
    v_lshl_add_u32 v27, v32, 4, v27
    v_and_b32 v31, 1, v26
    v_lshlrev_b32 v64, 3, v31
    v_sub_u32 v27, v27, v64
    v_mul_u32_u24 v28, 4160, v28
    v_lshl_add_u32 v64, v27, 1, v28
    s_lshl_b32 s65, s18, 8
    s_add_u32 s64, s64, s65
    v_add_u32 v64, s64, v64
    v_sub_u32 v65, v29, v32
    v_lshlrev_b32 v65, 5, v65
    v_lshl_add_u32 v65, v31, 4, v65
    s_mul_i32 s64, s17, 4608
    s_sub_u32 s64, s64, s65
    s_add_u32 s64, s64, 131904
    v_add_u32 v65, s64, v65
    s_lshl_b32 s64, s17, 4
    s_lshr_b32 s72, s72, s64
    s_lshl_b32 s72, s72, 16
    v_lshlrev_b32 v68, 5, v29
    v_lshl_add_u32 v68, v32, 4, v68
    v_and_b32 v27, 1, v26
    v_xor_b32 v27, 1, v27
    v_lshl_add_u32 v68, v27, 3, v68
    v_add_u32 v68, s4, v68
    s_waitcnt vmcnt(10)
    v_lshlrev_b32 v88, 16, v224
    v_and_b32 v89, 0xffff0000, v224
    v_lshlrev_b32 v90, 16, v225
    v_and_b32 v91, 0xffff0000, v225
    v_lshlrev_b32 v92, 16, v226
    v_and_b32 v93, 0xffff0000, v226
    v_lshlrev_b32 v94, 16, v227
    v_and_b32 v95, 0xffff0000, v227
    v_lshlrev_b32 v96, 16, v228
    v_and_b32 v97, 0xffff0000, v228
    v_lshlrev_b32 v98, 16, v229
    v_and_b32 v99, 0xffff0000, v229
    v_lshlrev_b32 v100, 16, v230
    v_and_b32 v101, 0xffff0000, v230
    v_lshlrev_b32 v102, 16, v231
    v_and_b32 v103, 0xffff0000, v231
    v_pk_add_f32 v[104:105], v[88:89], v[90:91]
    v_pk_add_f32 v[106:107], v[92:93], v[94:95]
    v_pk_add_f32 v[108:109], v[96:97], v[98:99]
    v_pk_add_f32 v[110:111], v[100:101], v[102:103]
    v_pk_add_f32 v[104:105], v[104:105], v[106:107]
    v_pk_add_f32 v[108:109], v[108:109], v[110:111]
    v_pk_add_f32 v[104:105], v[104:105], v[108:109]
    v_add_f32 v104, v104, v105
    s_nop 1
    v_add_f32_dpp v104, v104, v104 quad_perm:[1,0,3,2] row_mask:0xf bank_mask:0xf bound_ctrl:1
    s_nop 1
    v_add_f32_dpp v104, v104, v104 quad_perm:[2,3,0,1] row_mask:0xf bank_mask:0xf bound_ctrl:1
    s_nop 1
    v_add_f32_dpp v104, v104, v104 row_half_mirror row_mask:0xf bank_mask:0xf bound_ctrl:1
    s_nop 1
    v_add_f32_dpp v104, v104, v104 row_mirror row_mask:0xf bank_mask:0xf bound_ctrl:1
    v_mov_b32 v106, v104
    s_nop 1
    v_permlane16_swap_b32 v104, v106
    v_add_f32 v104, v104, v106
    v_mul_f32 v104, 0x3b000000, v104
    v_pk_add_f32 v[88:89], v[88:89], v[104:105] op_sel_hi:[1,0] neg_lo:[0,1] neg_hi:[0,1]
    v_pk_add_f32 v[90:91], v[90:91], v[104:105] op_sel_hi:[1,0] neg_lo:[0,1] neg_hi:[0,1]
    v_pk_add_f32 v[92:93], v[92:93], v[104:105] op_sel_hi:[1,0] neg_lo:[0,1] neg_hi:[0,1]
    v_pk_add_f32 v[94:95], v[94:95], v[104:105] op_sel_hi:[1,0] neg_lo:[0,1] neg_hi:[0,1]
    v_pk_add_f32 v[96:97], v[96:97], v[104:105] op_sel_hi:[1,0] neg_lo:[0,1] neg_hi:[0,1]
    v_pk_add_f32 v[98:99], v[98:99], v[104:105] op_sel_hi:[1,0] neg_lo:[0,1] neg_hi:[0,1]
    v_pk_add_f32 v[100:101], v[100:101], v[104:105] op_sel_hi:[1,0] neg_lo:[0,1] neg_hi:[0,1]
    v_pk_add_f32 v[102:103], v[102:103], v[104:105] op_sel_hi:[1,0] neg_lo:[0,1] neg_hi:[0,1]
    v_pk_mul_f32 v[106:107], v[88:89], v[88:89]
    v_pk_mul_f32 v[108:109], v[90:91], v[90:91]
    v_pk_fma_f32 v[106:107], v[92:93], v[92:93], v[106:107]
    v_pk_fma_f32 v[108:109], v[94:95], v[94:95], v[108:109]
    v_pk_fma_f32 v[106:107], v[96:97], v[96:97], v[106:107]
    v_pk_fma_f32 v[108:109], v[98:99], v[98:99], v[108:109]
    v_pk_fma_f32 v[106:107], v[100:101], v[100:101], v[106:107]
    v_pk_fma_f32 v[108:109], v[102:103], v[102:103], v[108:109]
    v_pk_add_f32 v[106:107], v[106:107], v[108:109]
    v_add_f32 v106, v106, v107
    s_nop 1
    v_add_f32_dpp v106, v106, v106 quad_perm:[1,0,3,2] row_mask:0xf bank_mask:0xf bound_ctrl:1
    s_nop 1
    v_add_f32_dpp v106, v106, v106 quad_perm:[2,3,0,1] row_mask:0xf bank_mask:0xf bound_ctrl:1
    s_nop 1
    v_add_f32_dpp v106, v106, v106 row_half_mirror row_mask:0xf bank_mask:0xf bound_ctrl:1
    s_nop 1
    v_add_f32_dpp v106, v106, v106 row_mirror row_mask:0xf bank_mask:0xf bound_ctrl:1
    v_mov_b32 v108, v106
    s_nop 1
    v_permlane16_swap_b32 v106, v108
    v_add_f32 v106, v106, v108
    v_mul_f32 v106, 0x3b000000, v106
    v_cvt_pk_bf16_f32 v106, v106, v106
    v_lshlrev_b32 v106, 16, v106
    v_add_f32 v106, 0x3727c5ac, v106
    v_cvt_pk_bf16_f32 v106, v106, v106
    v_lshlrev_b32 v106, 16, v106
    v_sqrt_f32 v106, v106
    v_mov_b32 v105, v22
    v_cvt_pk_bf16_f32 v104, v106, v104
    s_lshl_b32 s64, s62, 12
    s_lshl_b32 s65, s63, 7
    s_add_u32 s64, s64, s65
    s_lshl_b32 s65, s61, 4
    s_add_u32 s64, s64, s65
    s_add_u32 s64, s64, 65536
    v_lshl_add_u32 v29, v32, 3, s64
    s_mov_b32 exec_lo, 1
    s_mov_b32 exec_hi, 1
    buffer_store_dwordx2 v[104:105], v29, s[56:59], 0 offen sc1
    s_mov_b64 exec, -1
    s_waitcnt vmcnt(5)
    ds_read2_b32 v[236:237], v40 offset0:0 offset1:32
    ds_read2_b32 v[238:239], v40 offset0:64 offset1:96
    ds_read2_b32 v[240:241], v40 offset0:128 offset1:160
    ds_read2_b32 v[242:243], v40 offset0:192 offset1:224
    ds_read2_b32 v[244:245], v41 offset0:0 offset1:32
    ds_read_b32 v246, v41 offset:256
    ds_read2_b32 v[248:249], v42 offset0:0 offset1:32
    ds_read2_b32 v[250:251], v42 offset0:64 offset1:96
    ds_read2_b32 v[252:253], v42 offset0:128 offset1:160
    ds_read2_b32 v[254:255], v42 offset0:192 offset1:224
    v_lshlrev_b32 v112, 16, v232
    v_lshlrev_b32 v113, 16, v234
    v_and_b32 v114, 0xffff0000, v232
    v_and_b32 v115, 0xffff0000, v234
    v_lshlrev_b32 v116, 16, v233
    v_lshlrev_b32 v117, 16, v235
    v_and_b32 v118, 0xffff0000, v233
    v_and_b32 v119, 0xffff0000, v235
    s_waitcnt lgkmcnt(4)
    v_lshlrev_b32 v128, 16, v236
    v_and_b32 v129, 0xffff0000, v236
    v_lshlrev_b32 v130, 16, v237
    v_and_b32 v131, 0xffff0000, v237
    v_lshlrev_b32 v132, 16, v238
    v_and_b32 v133, 0xffff0000, v238
    v_lshlrev_b32 v134, 16, v239
    v_and_b32 v135, 0xffff0000, v239
    v_lshlrev_b32 v136, 16, v240
    v_and_b32 v137, 0xffff0000, v240
    v_lshlrev_b32 v138, 16, v241
    v_and_b32 v139, 0xffff0000, v241
    v_lshlrev_b32 v140, 16, v242
    v_and_b32 v141, 0xffff0000, v242
    v_lshlrev_b32 v142, 16, v243
    v_and_b32 v143, 0xffff0000, v243
    v_lshlrev_b32 v144, 16, v244
    v_and_b32 v145, 0xffff0000, v244
    v_lshlrev_b32 v146, 16, v245
    v_and_b32 v147, 0xffff0000, v245
    v_lshlrev_b32 v148, 16, v246
    v_and_b32 v149, 0xffff0000, v246
    v_pk_mul_f32 v[152:153], v[128:129], v[118:119]
    v_pk_mul_f32 v[154:155], v[130:131], v[118:119]
    v_pk_mul_f32 v[156:157], v[132:133], v[118:119]
    v_pk_mul_f32 v[158:159], v[134:135], v[118:119]
    v_pk_mul_f32 v[160:161], v[136:137], v[118:119]
    v_pk_mul_f32 v[162:163], v[138:139], v[118:119]
    v_pk_mul_f32 v[164:165], v[140:141], v[118:119]
    v_pk_mul_f32 v[166:167], v[142:143], v[118:119]
    v_cvt_pk_bf16_f32 v88, v152, v153
    v_cvt_pk_bf16_f32 v89, v154, v155
    v_cvt_pk_bf16_f32 v90, v156, v157
    v_cvt_pk_bf16_f32 v91, v158, v159
    v_cvt_pk_bf16_f32 v92, v160, v161
    v_cvt_pk_bf16_f32 v93, v162, v163
    v_cvt_pk_bf16_f32 v94, v164, v165
    v_cvt_pk_bf16_f32 v95, v166, v167
    v_lshlrev_b32 v152, 16, v88
    v_and_b32 v153, 0xffff0000, v88
    v_lshlrev_b32 v154, 16, v89
    v_and_b32 v155, 0xffff0000, v89
    v_lshlrev_b32 v156, 16, v90
    v_and_b32 v157, 0xffff0000, v90
    v_lshlrev_b32 v158, 16, v91
    v_and_b32 v159, 0xffff0000, v91
    v_lshlrev_b32 v160, 16, v92
    v_and_b32 v161, 0xffff0000, v92
    v_lshlrev_b32 v162, 16, v93
    v_and_b32 v163, 0xffff0000, v93
    v_lshlrev_b32 v164, 16, v94
    v_and_b32 v165, 0xffff0000, v94
    v_lshlrev_b32 v166, 16, v95
    v_and_b32 v167, 0xffff0000, v95
    v_pk_mul_f32 v[168:169], v[130:131], v[116:117]
    v_pk_mul_f32 v[170:171], v[132:133], v[116:117]
    v_pk_mul_f32 v[172:173], v[134:135], v[116:117]
    v_pk_mul_f32 v[174:175], v[136:137], v[116:117]
    v_pk_mul_f32 v[176:177], v[138:139], v[116:117]
    v_pk_mul_f32 v[178:179], v[140:141], v[116:117]
    v_pk_mul_f32 v[180:181], v[142:143], v[116:117]
    v_pk_mul_f32 v[182:183], v[144:145], v[116:117]
    v_cvt_pk_bf16_f32 v88, v168, v169
    v_cvt_pk_bf16_f32 v89, v170, v171
    v_cvt_pk_bf16_f32 v90, v172, v173
    v_cvt_pk_bf16_f32 v91, v174, v175
    v_cvt_pk_bf16_f32 v92, v176, v177
    v_cvt_pk_bf16_f32 v93, v178, v179
    v_cvt_pk_bf16_f32 v94, v180, v181
    v_cvt_pk_bf16_f32 v95, v182, v183
    v_lshlrev_b32 v168, 16, v88
    v_and_b32 v169, 0xffff0000, v88
    v_lshlrev_b32 v170, 16, v89
    v_and_b32 v171, 0xffff0000, v89
    v_lshlrev_b32 v172, 16, v90
    v_and_b32 v173, 0xffff0000, v90
    v_lshlrev_b32 v174, 16, v91
    v_and_b32 v175, 0xffff0000, v91
    v_lshlrev_b32 v176, 16, v92
    v_and_b32 v177, 0xffff0000, v92
    v_lshlrev_b32 v178, 16, v93
    v_and_b32 v179, 0xffff0000, v93
    v_lshlrev_b32 v180, 16, v94
    v_and_b32 v181, 0xffff0000, v94
    v_lshlrev_b32 v182, 16, v95
    v_and_b32 v183, 0xffff0000, v95
    v_pk_add_f32 v[152:153], v[152:153], v[168:169]
    v_pk_add_f32 v[154:155], v[154:155], v[170:171]
    v_pk_add_f32 v[156:157], v[156:157], v[172:173]
    v_pk_add_f32 v[158:159], v[158:159], v[174:175]
    v_pk_add_f32 v[160:161], v[160:161], v[176:177]
    v_pk_add_f32 v[162:163], v[162:163], v[178:179]
    v_pk_add_f32 v[164:165], v[164:165], v[180:181]
    v_pk_add_f32 v[166:167], v[166:167], v[182:183]
    v_cvt_pk_bf16_f32 v88, v152, v153
    v_cvt_pk_bf16_f32 v89, v154, v155
    v_cvt_pk_bf16_f32 v90, v156, v157
    v_cvt_pk_bf16_f32 v91, v158, v159
    v_cvt_pk_bf16_f32 v92, v160, v161
    v_cvt_pk_bf16_f32 v93, v162, v163
    v_cvt_pk_bf16_f32 v94, v164, v165
    v_cvt_pk_bf16_f32 v95, v166, v167
    v_lshlrev_b32 v152, 16, v88
    v_and_b32 v153, 0xffff0000, v88
    v_lshlrev_b32 v154, 16, v89
    v_and_b32 v155, 0xffff0000, v89
    v_lshlrev_b32 v156, 16, v90
    v_and_b32 v157, 0xffff0000, v90
    v_lshlrev_b32 v158, 16, v91
    v_and_b32 v159, 0xffff0000, v91
    v_lshlrev_b32 v160, 16, v92
    v_and_b32 v161, 0xffff0000, v92
    v_lshlrev_b32 v162, 16, v93
    v_and_b32 v163, 0xffff0000, v93
    v_lshlrev_b32 v164, 16, v94
    v_and_b32 v165, 0xffff0000, v94
    v_lshlrev_b32 v166, 16, v95
    v_and_b32 v167, 0xffff0000, v95
    v_pk_mul_f32 v[168:169], v[132:133], v[114:115]
    v_pk_mul_f32 v[170:171], v[134:135], v[114:115]
    v_pk_mul_f32 v[172:173], v[136:137], v[114:115]
    v_pk_mul_f32 v[174:175], v[138:139], v[114:115]
    v_pk_mul_f32 v[176:177], v[140:141], v[114:115]
    v_pk_mul_f32 v[178:179], v[142:143], v[114:115]
    v_pk_mul_f32 v[180:181], v[144:145], v[114:115]
    v_pk_mul_f32 v[182:183], v[146:147], v[114:115]
    v_cvt_pk_bf16_f32 v88, v168, v169
    v_cvt_pk_bf16_f32 v89, v170, v171
    v_cvt_pk_bf16_f32 v90, v172, v173
    v_cvt_pk_bf16_f32 v91, v174, v175
    v_cvt_pk_bf16_f32 v92, v176, v177
    v_cvt_pk_bf16_f32 v93, v178, v179
    v_cvt_pk_bf16_f32 v94, v180, v181
    v_cvt_pk_bf16_f32 v95, v182, v183
    v_lshlrev_b32 v168, 16, v88
    v_and_b32 v169, 0xffff0000, v88
    v_lshlrev_b32 v170, 16, v89
    v_and_b32 v171, 0xffff0000, v89
    v_lshlrev_b32 v172, 16, v90
    v_and_b32 v173, 0xffff0000, v90
    v_lshlrev_b32 v174, 16, v91
    v_and_b32 v175, 0xffff0000, v91
    v_lshlrev_b32 v176, 16, v92
    v_and_b32 v177, 0xffff0000, v92
    v_lshlrev_b32 v178, 16, v93
    v_and_b32 v179, 0xffff0000, v93
    v_lshlrev_b32 v180, 16, v94
    v_and_b32 v181, 0xffff0000, v94
    v_lshlrev_b32 v182, 16, v95
    v_and_b32 v183, 0xffff0000, v95
    v_pk_add_f32 v[152:153], v[152:153], v[168:169]
    v_pk_add_f32 v[154:155], v[154:155], v[170:171]
    v_pk_add_f32 v[156:157], v[156:157], v[172:173]
    v_pk_add_f32 v[158:159], v[158:159], v[174:175]
    v_pk_add_f32 v[160:161], v[160:161], v[176:177]
    v_pk_add_f32 v[162:163], v[162:163], v[178:179]
    v_pk_add_f32 v[164:165], v[164:165], v[180:181]
    v_pk_add_f32 v[166:167], v[166:167], v[182:183]
    v_cvt_pk_bf16_f32 v88, v152, v153
    v_cvt_pk_bf16_f32 v89, v154, v155
    v_cvt_pk_bf16_f32 v90, v156, v157
    v_cvt_pk_bf16_f32 v91, v158, v159
    v_cvt_pk_bf16_f32 v92, v160, v161
    v_cvt_pk_bf16_f32 v93, v162, v163
    v_cvt_pk_bf16_f32 v94, v164, v165
    v_cvt_pk_bf16_f32 v95, v166, v167
    v_lshlrev_b32 v152, 16, v88
    v_and_b32 v153, 0xffff0000, v88
    v_lshlrev_b32 v154, 16, v89
    v_and_b32 v155, 0xffff0000, v89
    v_lshlrev_b32 v156, 16, v90
    v_and_b32 v157, 0xffff0000, v90
    v_lshlrev_b32 v158, 16, v91
    v_and_b32 v159, 0xffff0000, v91
    v_lshlrev_b32 v160, 16, v92
    v_and_b32 v161, 0xffff0000, v92
    v_lshlrev_b32 v162, 16, v93
    v_and_b32 v163, 0xffff0000, v93
    v_lshlrev_b32 v164, 16, v94
    v_and_b32 v165, 0xffff0000, v94
    v_lshlrev_b32 v166, 16, v95
    v_and_b32 v167, 0xffff0000, v95
    v_pk_mul_f32 v[168:169], v[134:135], v[112:113]
    v_pk_mul_f32 v[170:171], v[136:137], v[112:113]
    v_pk_mul_f32 v[172:173], v[138:139], v[112:113]
    v_pk_mul_f32 v[174:175], v[140:141], v[112:113]
    v_pk_mul_f32 v[176:177], v[142:143], v[112:113]
    v_pk_mul_f32 v[178:179], v[144:145], v[112:113]
    v_pk_mul_f32 v[180:181], v[146:147], v[112:113]
    v_pk_mul_f32 v[182:183], v[148:149], v[112:113]
    v_cvt_pk_bf16_f32 v88, v168, v169
    v_cvt_pk_bf16_f32 v89, v170, v171
    v_cvt_pk_bf16_f32 v90, v172, v173
    v_cvt_pk_bf16_f32 v91, v174, v175
    v_cvt_pk_bf16_f32 v92, v176, v177
    v_cvt_pk_bf16_f32 v93, v178, v179
    v_cvt_pk_bf16_f32 v94, v180, v181
    v_cvt_pk_bf16_f32 v95, v182, v183
    v_lshlrev_b32 v168, 16, v88
    v_and_b32 v169, 0xffff0000, v88
    v_lshlrev_b32 v170, 16, v89
    v_and_b32 v171, 0xffff0000, v89
    v_lshlrev_b32 v172, 16, v90
    v_and_b32 v173, 0xffff0000, v90
    v_lshlrev_b32 v174, 16, v91
    v_and_b32 v175, 0xffff0000, v91
    v_lshlrev_b32 v176, 16, v92
    v_and_b32 v177, 0xffff0000, v92
    v_lshlrev_b32 v178, 16, v93
    v_and_b32 v179, 0xffff0000, v93
    v_lshlrev_b32 v180, 16, v94
    v_and_b32 v181, 0xffff0000, v94
    v_lshlrev_b32 v182, 16, v95
    v_and_b32 v183, 0xffff0000, v95
    v_pk_add_f32 v[152:153], v[152:153], v[168:169]
    v_pk_add_f32 v[154:155], v[154:155], v[170:171]
    v_pk_add_f32 v[156:157], v[156:157], v[172:173]
    v_pk_add_f32 v[158:159], v[158:159], v[174:175]
    v_pk_add_f32 v[160:161], v[160:161], v[176:177]
    v_pk_add_f32 v[162:163], v[162:163], v[178:179]
    v_pk_add_f32 v[164:165], v[164:165], v[180:181]
    v_pk_add_f32 v[166:167], v[166:167], v[182:183]
    v_cvt_pk_bf16_f32 v88, v152, v153
    v_cvt_pk_bf16_f32 v89, v154, v155
    v_cvt_pk_bf16_f32 v90, v156, v157
    v_cvt_pk_bf16_f32 v91, v158, v159
    v_cvt_pk_bf16_f32 v92, v160, v161
    v_cvt_pk_bf16_f32 v93, v162, v163
    v_cvt_pk_bf16_f32 v94, v164, v165
    v_cvt_pk_bf16_f32 v95, v166, v167
    v_lshlrev_b32 v152, 16, v88
    v_and_b32 v153, 0xffff0000, v88
    v_lshlrev_b32 v154, 16, v89
    v_and_b32 v155, 0xffff0000, v89
    v_lshlrev_b32 v156, 16, v90
    v_and_b32 v157, 0xffff0000, v90
    v_lshlrev_b32 v158, 16, v91
    v_and_b32 v159, 0xffff0000, v91
    v_lshlrev_b32 v160, 16, v92
    v_and_b32 v161, 0xffff0000, v92
    v_lshlrev_b32 v162, 16, v93
    v_and_b32 v163, 0xffff0000, v93
    v_lshlrev_b32 v164, 16, v94
    v_and_b32 v165, 0xffff0000, v94
    v_lshlrev_b32 v166, 16, v95
    v_and_b32 v167, 0xffff0000, v95
    s_waitcnt lgkmcnt(0)
    v_lshlrev_b32 v128, 16, v248
    v_and_b32 v129, 0xffff0000, v248
    v_lshlrev_b32 v130, 16, v249
    v_and_b32 v131, 0xffff0000, v249
    v_lshlrev_b32 v132, 16, v250
    v_and_b32 v133, 0xffff0000, v250
    v_lshlrev_b32 v134, 16, v251
    v_and_b32 v135, 0xffff0000, v251
    v_lshlrev_b32 v136, 16, v252
    v_and_b32 v137, 0xffff0000, v252
    v_lshlrev_b32 v138, 16, v253
    v_and_b32 v139, 0xffff0000, v253
    v_lshlrev_b32 v140, 16, v254
    v_and_b32 v141, 0xffff0000, v254
    v_lshlrev_b32 v142, 16, v255
    v_and_b32 v143, 0xffff0000, v255
    v_pk_mul_f32 v[152:153], v[152:153], v[128:129]
    v_pk_mul_f32 v[154:155], v[154:155], v[130:131]
    v_pk_mul_f32 v[156:157], v[156:157], v[132:133]
    v_pk_mul_f32 v[158:159], v[158:159], v[134:135]
    v_pk_mul_f32 v[160:161], v[160:161], v[136:137]
    v_pk_mul_f32 v[162:163], v[162:163], v[138:139]
    v_pk_mul_f32 v[164:165], v[164:165], v[140:141]
    v_pk_mul_f32 v[166:167], v[166:167], v[142:143]
    v_cvt_pk_bf16_f32 v112, v166, v164
    v_cvt_pk_bf16_f32 v113, v162, v160
    v_cvt_pk_bf16_f32 v114, v158, v156
    v_cvt_pk_bf16_f32 v115, v154, v152
    v_cvt_pk_bf16_f32 v116, v167, v165
    v_cvt_pk_bf16_f32 v117, v163, v161
    v_cvt_pk_bf16_f32 v118, v159, v157
    v_cvt_pk_bf16_f32 v119, v155, v153
    ds_write_b128 v43, v[112:115]
    ds_write_b128 v43, v[116:119] offset:128
    s_waitcnt lgkmcnt(0)
    s_barrier
    ds_read_b128 v[232:235], v18
    ds_read_b128 v[236:239], v19 offset:1024
    v_mov_b32 v37, 0
    ds_write_b32 v67, v37
    s_waitcnt lgkmcnt(2)
    buffer_store_dwordx4 v[232:235], v63, s[56:59], 0 offen sc1
    s_waitcnt lgkmcnt(1)
    buffer_store_dwordx4 v[236:239], v63, s[56:59], s16 offen sc1
    s_waitcnt vmcnt(0)
    s_mov_b64 exec, 1
    buffer_store_dword v22, v23, s[56:59], 0 offen offset:48 sc1
    s_mov_b64 exec, -1
    v_lshrrev_b32 v26, 2, v1
    v_lshlrev_b32 v26, 10, v26
    v_and_b32 v27, 3, v1
    v_lshl_add_u32 v88, v27, 7, v26
    s_sub_u32 s69, s63, 28
    s_and_b32 s70, s62, 1
    s_mul_i32 s64, s69, 458752
    s_lshl_b32 s65, s61, 14
    s_add_u32 s64, s64, s65
    s_lshl_b32 s65, s70, 9
    s_add_u32 s64, s64, s65
    buffer_load_dword v90, v88, s[48:51], s64 offen
    s_add_u32 s64, s64, 65536
    buffer_load_dword v91, v88, s[48:51], s64 offen
    s_add_u32 s64, s64, 65536
    buffer_load_dword v92, v88, s[48:51], s64 offen
    s_add_u32 s64, s64, 65536
    buffer_load_dword v93, v88, s[48:51], s64 offen
    s_add_u32 s64, s64, 65536
    buffer_load_dword v94, v88, s[48:51], s64 offen
    s_add_u32 s64, s64, 65536
    buffer_load_dword v95, v88, s[48:51], s64 offen
    s_add_u32 s64, s64, 65536
    buffer_load_dword v96, v88, s[48:51], s64 offen
    s_add_u32 s64, s64, 65536
    buffer_load_dword v37, v36, s[56:59], 0 offen sc1
    v_mov_b64 v[216:217], 0
    v_mov_b64 v[218:219], 0
    s_mov_b64 exec, 255
    ds_write_b128 v66, v[216:219]
    s_mov_b64 exec, -1
    ds_write_b128 v83, v[46:49] offset:0
    v_alignbit_b32 v220, v46, v45, 16
    v_alignbit_b32 v221, v47, v46, 16
    v_alignbit_b32 v222, v48, v47, 16
    v_alignbit_b32 v223, v49, v48, 16
    ds_write_b128 v83, v[220:223] offset:4160
    v_mov_b32 v224, v45
    v_mov_b32 v225, v46
    v_mov_b32 v226, v47
    v_mov_b32 v227, v48
    ds_write_b128 v83, v[224:227] offset:8320
    v_alignbit_b32 v228, v45, v44, 16
    v_alignbit_b32 v229, v46, v45, 16
    v_alignbit_b32 v230, v47, v46, 16
    v_alignbit_b32 v231, v48, v47, 16
    ds_write_b128 v83, v[228:231] offset:12480
    ds_write_b128 v83, v[52:55] offset:1024
    v_alignbit_b32 v220, v52, v51, 16
    v_alignbit_b32 v221, v53, v52, 16
    v_alignbit_b32 v222, v54, v53, 16
    v_alignbit_b32 v223, v55, v54, 16
    ds_write_b128 v83, v[220:223] offset:5184
    v_mov_b32 v224, v51
    v_mov_b32 v225, v52
    v_mov_b32 v226, v53
    v_mov_b32 v227, v54
    ds_write_b128 v83, v[224:227] offset:9344
    v_alignbit_b32 v228, v51, v50, 16
    v_alignbit_b32 v229, v52, v51, 16
    v_alignbit_b32 v230, v53, v52, 16
    v_alignbit_b32 v231, v54, v53, 16
    ds_write_b128 v83, v[228:231] offset:13504
    v_add_u32 v14, 65536, v21
    v_add_u32 v15, 65536, v0
    s_lshl_b32 s3, s73, 4
    s_add_u32 m0, s19, 0
    s_nop 0
    buffer_load_dwordx4 v16, s[48:51], s3 offen offset:0 lds
    buffer_load_dwordx4 v17, s[48:51], s3 offen offset:1024 lds
    s_add_u32 m0, s19, 0
    s_nop 0
    buffer_load_dwordx4 v20, s[48:51], s3 offen offset:2048 lds
    buffer_load_dwordx4 v24, s[48:51], s3 offen offset:3072 lds
    s_add_u32 s3, s3, 32768
    s_add_u32 m0, s19, 4096
    s_nop 0
    buffer_load_dwordx4 v16, s[48:51], s3 offen offset:0 lds
    buffer_load_dwordx4 v17, s[48:51], s3 offen offset:1024 lds
    s_add_u32 m0, s19, 4096
    s_nop 0
    buffer_load_dwordx4 v20, s[48:51], s3 offen offset:2048 lds
    buffer_load_dwordx4 v24, s[48:51], s3 offen offset:3072 lds
    s_lshl_b32 s3, s74, 4
    s_add_u32 m0, s19, 32768
    s_nop 0
    buffer_load_dwordx4 v16, s[48:51], s3 offen offset:0 lds
    buffer_load_dwordx4 v17, s[48:51], s3 offen offset:1024 lds
    s_add_u32 m0, s19, 32768
    s_nop 0
    buffer_load_dwordx4 v20, s[48:51], s3 offen offset:2048 lds
    buffer_load_dwordx4 v24, s[48:51], s3 offen offset:3072 lds
    s_add_u32 s3, s3, 32768
    s_add_u32 m0, s19, 36864
    s_nop 0
    buffer_load_dwordx4 v16, s[48:51], s3 offen offset:0 lds
    buffer_load_dwordx4 v17, s[48:51], s3 offen offset:1024 lds
    s_add_u32 m0, s19, 36864
    s_nop 0
    buffer_load_dwordx4 v20, s[48:51], s3 offen offset:2048 lds
    buffer_load_dwordx4 v24, s[48:51], s3 offen offset:3072 lds
    s_lshl_b32 s3, s75, 4
    s_add_u32 m0, s19, 65536
    s_nop 0
    buffer_load_dwordx4 v16, s[48:51], s3 offen offset:0 lds
    buffer_load_dwordx4 v17, s[48:51], s3 offen offset:1024 lds
    s_add_u32 m0, s19, 65536
    s_nop 0
    buffer_load_dwordx4 v20, s[48:51], s3 offen offset:2048 lds
    buffer_load_dwordx4 v24, s[48:51], s3 offen offset:3072 lds
    s_add_u32 s3, s3, 32768
    s_add_u32 m0, s19, 69632
    s_nop 0
    buffer_load_dwordx4 v16, s[48:51], s3 offen offset:0 lds
    buffer_load_dwordx4 v17, s[48:51], s3 offen offset:1024 lds
    s_add_u32 m0, s19, 69632
    s_nop 0
    buffer_load_dwordx4 v20, s[48:51], s3 offen offset:2048 lds
    buffer_load_dwordx4 v24, s[48:51], s3 offen offset:3072 lds
    s_waitcnt vmcnt(16)
    ds_read_b64_tr_b16 a[0:1], v21 offset:0
    ds_read_b64_tr_b16 a[2:3], v21 offset:1024
    ds_read_b64_tr_b16 a[4:5], v0 offset:0
    ds_read_b64_tr_b16 a[6:7], v0 offset:1024
    ds_read_b64_tr_b16 a[8:9], v21 offset:2048
    ds_read_b64_tr_b16 a[10:11], v21 offset:3072
    ds_read_b64_tr_b16 a[12:13], v0 offset:2048
    ds_read_b64_tr_b16 a[14:15], v0 offset:3072
    ds_read_b64_tr_b16 a[16:17], v21 offset:4096
    ds_read_b64_tr_b16 a[18:19], v21 offset:5120
    ds_read_b64_tr_b16 a[20:21], v0 offset:4096
    ds_read_b64_tr_b16 a[22:23], v0 offset:5120
    ds_read_b64_tr_b16 a[24:25], v21 offset:6144
    ds_read_b64_tr_b16 a[26:27], v21 offset:7168
    ds_read_b64_tr_b16 a[28:29], v0 offset:6144
    ds_read_b64_tr_b16 a[30:31], v0 offset:7168
    s_waitcnt lgkmcnt(0)
    s_lshl_b32 s3, s76, 4
    s_add_u32 m0, s19, 0
    s_nop 0
    buffer_load_dwordx4 v16, s[48:51], s3 offen offset:0 lds
    buffer_load_dwordx4 v17, s[48:51], s3 offen offset:1024 lds
    s_add_u32 m0, s19, 0
    s_nop 0
    buffer_load_dwordx4 v20, s[48:51], s3 offen offset:2048 lds
    buffer_load_dwordx4 v24, s[48:51], s3 offen offset:3072 lds
    s_add_u32 s3, s3, 32768
    s_add_u32 m0, s19, 4096
    s_nop 0
    buffer_load_dwordx4 v16, s[48:51], s3 offen offset:0 lds
    buffer_load_dwordx4 v17, s[48:51], s3 offen offset:1024 lds
    s_add_u32 m0, s19, 4096
    s_nop 0
    buffer_load_dwordx4 v20, s[48:51], s3 offen offset:2048 lds
    buffer_load_dwordx4 v24, s[48:51], s3 offen offset:3072 lds
    v_cmp_ne_u32 vcc, s60, v37
    s_nop 4
    s_cbranch_vccz L_ok_5
    s_mov_b32 s96, 200000
L_spin_6:
    s_sleep 2
    buffer_load_dword v37, v36, s[56:59], 0 offen sc1
    s_waitcnt vmcnt(0)
    s_sub_u32 s96, s96, 1
    s_cbranch_scc1 L_ok_5
    v_cmp_ne_u32 vcc, s60, v37
    s_nop 4
    s_cbranch_vccnz L_spin_6
L_ok_5:
    buffer_load_dwordx2 v[42:43], v80, s[56:59], 0 offen sc1
    s_mov_b32 m0, s4
    s_nop 0
    buffer_load_dwordx4 v78, s[56:59], 0 offen sc1 lds
    buffer_load_dwordx4 v78, s[56:59], 0 offen offset:1024 sc1 lds
    v_mov_b32 v38, v23
    s_waitcnt vmcnt(0) lgkmcnt(0)
    s_barrier
    s_branch L_conv
L_end:
    s_endpgm
.section .rodata,"a"
.p2align 6
.amdhsa_kernel recurrent_scan__ssm_conv_h3__dense_activation_silu__prompt_kernel
  .amdhsa_next_free_vgpr 512
  .amdhsa_next_free_sgpr 102
  .amdhsa_accum_offset 256
  .amdhsa_group_segment_fixed_size 0
  .amdhsa_kernarg_size 96
  .amdhsa_user_sgpr_count 2
  .amdhsa_user_sgpr_kernarg_segment_ptr 1
  .amdhsa_system_sgpr_workgroup_id_x 1
.end_amdhsa_kernel
```
